```python
import torch

def _softmax(x, axis=-1):
    return torch.softmax(x, dim=axis)
def _gelu(x):
    return torch.nn.functional.gelu(x, approximate="tanh")
def _silu(x):
    return torch.nn.functional.silu(x)
def _sigmoid(x):
    return torch.sigmoid(x)
def _layernorm(x, axis=-1, eps=1e-5):
    m = x.mean(dim=axis, keepdim=True)
    v = x.var(dim=axis, keepdim=True, unbiased=False)
    return (x - m) / torch.sqrt(v + eps)
def _scatter_add(tgt, idx, src, axis=0):
    return tgt.clone().index_add_(axis, idx, src)
def _segment_sum(src, seg, n):
    out = torch.zeros((n,) + src.shape[1:], dtype=src.dtype)
    return out.index_add_(0, seg, src)
def _pad(x, pw):
    flat = tuple(v for pair in reversed(pw) for v in pair)
    return torch.nn.functional.pad(x, flat)

kernel_name = 'parallel_sum__mha_block_cached__swiglu_ffn__decode'

def setup_inputs():

    _w = (lambda a: (lambda t: t.to(torch.bfloat16) if t.is_floating_point() else t)(torch.as_tensor(a)))
    def _A_setup():
        B, Sq, D = 4, 1, 512
        H, Sk, Dh = 32, 8192, 128
        return {
            "x": _w((lambda *s: torch.randn(*s, dtype=torch.bfloat16) * 0.05)(B, Sq, D)),
            "k_cache": _w((lambda *s: torch.randn(*s, dtype=torch.bfloat16) * 3.2)(B, H, Sk, Dh)),
            "v_cache": _w((lambda *s: torch.randn(*s, dtype=torch.bfloat16) * 1.6)(B, H, Sk, Dh)),
            "wq": _w((lambda *s: torch.randn(*s, dtype=torch.bfloat16) * 3.2)(D, H * Dh) * (D ** -0.5)),
            "wo": _w((lambda *s: torch.randn(*s, dtype=torch.bfloat16) * 1.6)(H * Dh, D) * ((H * Dh) ** -0.5)),
        }
    _A_in = _A_setup()

    def _B_setup():
        B, S, D, F = 4, 1, 512, 1792
        return {
            "x": _w((lambda *s: torch.randn(*s, dtype=torch.bfloat16) * 0.05)(B, S, D)),
            "w_gate": _w((lambda *s: torch.randn(*s, dtype=torch.bfloat16) * 0.05)(D, F)),
            "w_up": _w((lambda *s: torch.randn(*s, dtype=torch.bfloat16) * 0.05)(D, F)),
            "w_down": _w((lambda *s: torch.randn(*s, dtype=torch.bfloat16) * 0.05)(F, D)),
        }
    _B_in = _B_setup()

    return {
        "A_x": _A_in["x"],
        "A_k_cache": _A_in["k_cache"],
        "A_v_cache": _A_in["v_cache"],
        "A_wq": _A_in["wq"],
        "A_wo": _A_in["wo"],
        "B_x": _B_in["x"],
        "B_w_gate": _B_in["w_gate"],
        "B_w_up": _B_in["w_up"],
        "B_w_down": _B_in["w_down"],
    }

def reference(A_x, A_k_cache, A_v_cache, A_wq, A_wo, B_x, B_w_gate, B_w_up, B_w_down):
    def _A_ref(x, k_cache, v_cache, wq, wo):
        B, Sq, D = x.shape
        H, Dh = 32, 128
        q = (lambda x, *d: x.permute(*d))((x @ wq).reshape(B, Sq, H, Dh), 0, 2, 1, 3)
        scores = torch.einsum("bhqd,bhkd->bhqk", q, k_cache) * (Dh ** -0.5)
        p = _softmax(scores, axis=-1)
        o = torch.einsum("bhqk,bhkd->bhqd", p, v_cache)
        return (lambda x, *d: x.permute(*d))(o, 0, 2, 1, 3).reshape(B, Sq, H * Dh) @ wo

    def _B_ref(x, w_gate, w_up, w_down):
        g = _silu(x @ w_gate)
        u = x @ w_up
        return (g * u) @ w_down

    x = A_x
    xn = _layernorm(x, axis=-1)
    return x + _A_ref(xn, A_k_cache, A_v_cache, A_wq, A_wo) + _B_ref(xn, B_w_gate, B_w_up, B_w_down)
```

```asm
; @launch kernel=parallel_sum__mha_block_cached__swiglu_ffn__decode_kernel grid=(256,1,1) block=(512,1,1) lds=35328
; @launch kernel=final_reduce_kernel grid=(32,1,1) block=(256,1,1) lds=2048
.amdgcn_target "amdgcn-amd-amdhsa--gfx950"
.text
.globl parallel_sum__mha_block_cached__swiglu_ffn__decode_kernel
.p2align 8
.type parallel_sum__mha_block_cached__swiglu_ffn__decode_kernel,@function
parallel_sum__mha_block_cached__swiglu_ffn__decode_kernel:
  s_cmp_ge_u32 s2, 256
  s_cbranch_scc1 L1_done
  s_load_dwordx16 s[36:51], s[0:1], 0
  s_load_dwordx8 s[52:59], s[0:1], 64
  v_lshrrev_b32 v60, 6, v0
  v_and_b32 v1, 63, v0
  v_readfirstlane_b32 s23, v60
  s_and_b32 s27, s2, 7
  s_lshr_b32 s28, s2, 4
  s_lshl_b32 s28, s28, 3
  s_add_u32 s83, s27, s28
  s_lshr_b32 s84, s2, 3
  s_and_b32 s84, s84, 1
  s_lshr_b32 s24, s83, 5
  s_and_b32 s25, s83, 31
  s_lshl_b32 s26, s25, 1
  s_add_u32 s26, s26, s84
  s_lshl_b32 s21, s83, 21
  s_mul_i32 s27, s84, 1048576
  s_mov_b32 s73, 16384
  s_add_u32 s85, s21, s27
  s_lshl_b32 s82, s24, 6
  s_add_u32 s82, s82, s26
  s_lshl_b32 s82, s82, 11
  s_mov_b32 s31, 0xffff0000
  s_mov_b32 s80, 1069066811
  v_and_b32 v60, 15, v1
  v_lshlrev_b32 v60, 4, v60
  v_lshrrev_b32 v61, 4, v1
  v_lshl_add_u32 v5, v61, 2, v60
  v_mov_b32 v63, 0
  v_lshlrev_b32 v62, 2, v0
  s_cmp_ge_u32 s23, 1
  s_cbranch_scc1 L1_noinit
  ds_write_b32 v62, v63
L1_noinit:
  s_nop 4
  s_waitcnt lgkmcnt(0)
  s_mov_b32 s16, s58
  s_mov_b32 s17, s59
  s_mov_b32 s18, 4194304
  s_mov_b32 s19, 0x00020000
  s_cmp_ge_u32 s23, 4
  s_cbranch_scc1 L1_aux
  s_mov_b32 s8, s38
  s_mov_b32 s9, s39
  s_mov_b32 s10, 268435456
  s_mov_b32 s11, 0x00020000
  s_lshl_b32 s27, s23, 12
  v_lshl_add_u32 v2, v1, 4, s27
  s_mov_b32 s75, s85
  s_add_u32 s76, s85, 1048576
  s_mov_b32 s60, s85
  buffer_load_dwordx4 v[64:67], v2, s[8:11], s60 offen offset:0 nt
  buffer_load_dwordx4 v[68:71], v2, s[8:11], s60 offen offset:1024 nt
  buffer_load_dwordx4 v[72:75], v2, s[8:11], s60 offen offset:2048 nt
  buffer_load_dwordx4 v[76:79], v2, s[8:11], s60 offen offset:3072 nt
  s_add_u32 s60, s60, s73
  buffer_load_dwordx4 v[80:83], v2, s[8:11], s60 offen offset:0 nt
  buffer_load_dwordx4 v[84:87], v2, s[8:11], s60 offen offset:1024 nt
  buffer_load_dwordx4 v[88:91], v2, s[8:11], s60 offen offset:2048 nt
  buffer_load_dwordx4 v[92:95], v2, s[8:11], s60 offen offset:3072 nt
  s_add_u32 s60, s60, s73
  s_barrier
  buffer_load_dwordx4 v[96:99], v2, s[8:11], s60 offen offset:0 nt
  buffer_load_dwordx4 v[100:103], v2, s[8:11], s60 offen offset:1024 nt
  buffer_load_dwordx4 v[104:107], v2, s[8:11], s60 offen offset:2048 nt
  buffer_load_dwordx4 v[108:111], v2, s[8:11], s60 offen offset:3072 nt
  s_add_u32 s60, s60, s73
  buffer_load_dwordx4 v[112:115], v2, s[8:11], s60 offen offset:0 nt
  buffer_load_dwordx4 v[116:119], v2, s[8:11], s60 offen offset:1024 nt
  buffer_load_dwordx4 v[120:123], v2, s[8:11], s60 offen offset:2048 nt
  buffer_load_dwordx4 v[124:127], v2, s[8:11], s60 offen offset:3072 nt
  s_add_u32 s60, s60, s73
  s_mov_b32 s32, 0xcccccccc
  s_mov_b32 s33, 0xcccccccc
  s_mov_b32 s34, 0xaaaaaaaa
  s_mov_b32 s35, 0xaaaaaaaa
  s_mov_b32 s81, 1035273459
  s_mov_b32 s61, 3
  s_add_u32 s27, s27, 16384
  v_lshl_add_u32 v3, v1, 2, s27
  v_mov_b32 v4, v3
  v_mov_b32 v9, 0xff800000
  v_mov_b32 v10, 0
  v_mov_b32 v20, 0
  v_mov_b32 v21, 0
  v_mov_b32 v22, 0
  v_mov_b32 v23, 0
  v_mov_b32 v24, 0
  v_mov_b32 v25, 0
  v_mov_b32 v26, 0
  v_mov_b32 v27, 0
  buffer_load_dwordx4 v[128:131], v2, s[8:11], s60 offen offset:0 nt
  buffer_load_dwordx4 v[132:135], v2, s[8:11], s60 offen offset:1024 nt
  buffer_load_dwordx4 v[136:139], v2, s[8:11], s60 offen offset:2048 nt
  buffer_load_dwordx4 v[140:143], v2, s[8:11], s60 offen offset:3072 nt
  s_add_u32 s60, s60, s73
  buffer_load_dwordx4 v[144:147], v2, s[8:11], s60 offen offset:0 nt
  buffer_load_dwordx4 v[148:151], v2, s[8:11], s60 offen offset:1024 nt
  buffer_load_dwordx4 v[152:155], v2, s[8:11], s60 offen offset:2048 nt
  buffer_load_dwordx4 v[156:159], v2, s[8:11], s60 offen offset:3072 nt
  s_add_u32 s60, s60, s73
  buffer_load_dwordx4 v[160:163], v2, s[8:11], s60 offen offset:0 nt
  buffer_load_dwordx4 v[164:167], v2, s[8:11], s60 offen offset:1024 nt
  buffer_load_dwordx4 v[168:171], v2, s[8:11], s60 offen offset:2048 nt
  buffer_load_dwordx4 v[172:175], v2, s[8:11], s60 offen offset:3072 nt
  s_add_u32 s60, s60, s73
  buffer_load_dwordx4 v[176:179], v2, s[8:11], s60 offen offset:0 nt
  buffer_load_dwordx4 v[180:183], v2, s[8:11], s60 offen offset:1024 nt
  buffer_load_dwordx4 v[184:187], v2, s[8:11], s60 offen offset:2048 nt
  buffer_load_dwordx4 v[188:191], v2, s[8:11], s60 offen offset:3072 nt
  s_add_u32 s60, s60, s73
  buffer_load_dwordx4 v[192:195], v2, s[8:11], s60 offen offset:0 nt
  buffer_load_dwordx4 v[196:199], v2, s[8:11], s60 offen offset:1024 nt
  buffer_load_dwordx4 v[200:203], v2, s[8:11], s60 offen offset:2048 nt
  buffer_load_dwordx4 v[204:207], v2, s[8:11], s60 offen offset:3072 nt
  s_add_u32 s60, s60, s73
  buffer_load_dwordx4 v[208:211], v2, s[8:11], s60 offen offset:0 nt
  buffer_load_dwordx4 v[212:215], v2, s[8:11], s60 offen offset:1024 nt
  buffer_load_dwordx4 v[216:219], v2, s[8:11], s60 offen offset:2048 nt
  buffer_load_dwordx4 v[220:223], v2, s[8:11], s60 offen offset:3072 nt
  s_add_u32 s60, s60, s73
  buffer_load_dwordx4 v[224:227], v2, s[8:11], s60 offen offset:0 nt
  buffer_load_dwordx4 v[228:231], v2, s[8:11], s60 offen offset:1024 nt
  buffer_load_dwordx4 v[232:235], v2, s[8:11], s60 offen offset:2048 nt
  buffer_load_dwordx4 v[236:239], v2, s[8:11], s60 offen offset:3072 nt
  s_add_u32 s60, s60, s73
  buffer_load_dwordx4 v[240:243], v2, s[8:11], s60 offen offset:0 nt
  buffer_load_dwordx4 v[244:247], v2, s[8:11], s60 offen offset:1024 nt
  buffer_load_dwordx4 v[248:251], v2, s[8:11], s60 offen offset:2048 nt
  buffer_load_dwordx4 v[252:255], v2, s[8:11], s60 offen offset:3072 nt
  s_add_u32 s60, s60, s73
  v_mov_b32 v61, 0
L1_qpoll:
  s_nop 4
  ds_read_b128 v[28:31], v61
  s_waitcnt lgkmcnt(0)
  v_and_b32 v28, v28, v29
  v_and_b32 v30, v30, v31
  v_and_b32 v28, v28, v30
  s_nop 0
  v_readfirstlane_b32 s27, v28
  s_nop 0
  s_cmp_eq_u32 s27, 1
  s_cbranch_scc1 L1_qpoll_ok
  s_sleep 1
  s_branch L1_qpoll
L1_qpoll_ok:
  s_nop 4
  v_and_b32 v61, 15, v1
  v_lshlrev_b32 v61, 5, v61
  ds_read_b128 v[36:39], v61 offset:33280
  ds_read_b128 v[40:43], v61 offset:33296
  ds_read_b128 v[44:47], v61 offset:33792
  ds_read_b128 v[48:51], v61 offset:33808
  ds_read_b128 v[28:31], v61 offset:34304
  ds_read_b128 v[32:35], v61 offset:34320
  ds_read_b128 v[52:55], v61 offset:34816
  ds_read_b128 v[56:59], v61 offset:34832
  s_waitcnt lgkmcnt(0)
  v_add_f32 v36, v36, v44
  v_add_f32 v28, v28, v52
  v_add_f32 v36, v36, v28
  v_add_f32 v37, v37, v45
  v_add_f32 v29, v29, v53
  v_add_f32 v37, v37, v29
  v_add_f32 v38, v38, v46
  v_add_f32 v30, v30, v54
  v_add_f32 v38, v38, v30
  v_add_f32 v39, v39, v47
  v_add_f32 v31, v31, v55
  v_add_f32 v39, v39, v31
  v_add_f32 v40, v40, v48
  v_add_f32 v32, v32, v56
  v_add_f32 v40, v40, v32
  v_add_f32 v41, v41, v49
  v_add_f32 v33, v33, v57
  v_add_f32 v41, v41, v33
  v_add_f32 v42, v42, v50
  v_add_f32 v34, v34, v58
  v_add_f32 v42, v42, v34
  v_add_f32 v43, v43, v51
  v_add_f32 v35, v35, v59
  v_add_f32 v43, v43, v35
  v_cvt_pk_bf16_f32 v14, v36, v37
  v_cvt_pk_bf16_f32 v15, v38, v39
  v_cvt_pk_bf16_f32 v16, v40, v41
  v_cvt_pk_bf16_f32 v17, v42, v43
L1_kloop:
  s_nop 4
  s_cmp_eq_u32 s61, 16
  s_cselect_b32 s8, s40, s8
  s_cselect_b32 s9, s41, s9
  s_cselect_b32 s60, s85, s60
  s_add_u32 s61, s61, 1
  s_waitcnt vmcnt(47)
  v_dot2_f32_bf16 v36, v64, v14, 0
  v_dot2_f32_bf16 v36, v65, v15, v36
  v_dot2_f32_bf16 v36, v66, v16, v36
  v_dot2_f32_bf16 v36, v67, v17, v36
  buffer_load_dwordx4 v[64:67], v2, s[8:11], s60 offen offset:0 nt
  s_waitcnt vmcnt(47)
  v_dot2_f32_bf16 v37, v68, v14, 0
  v_dot2_f32_bf16 v37, v69, v15, v37
  v_dot2_f32_bf16 v37, v70, v16, v37
  v_dot2_f32_bf16 v37, v71, v17, v37
  buffer_load_dwordx4 v[68:71], v2, s[8:11], s60 offen offset:1024 nt
  s_waitcnt vmcnt(47)
  v_dot2_f32_bf16 v38, v72, v14, 0
  v_dot2_f32_bf16 v38, v73, v15, v38
  v_dot2_f32_bf16 v38, v74, v16, v38
  v_dot2_f32_bf16 v38, v75, v17, v38
  buffer_load_dwordx4 v[72:75], v2, s[8:11], s60 offen offset:2048 nt
  s_waitcnt vmcnt(47)
  v_dot2_f32_bf16 v39, v76, v14, 0
  v_dot2_f32_bf16 v39, v77, v15, v39
  v_dot2_f32_bf16 v39, v78, v16, v39
  v_dot2_f32_bf16 v39, v79, v17, v39
  buffer_load_dwordx4 v[76:79], v2, s[8:11], s60 offen offset:3072 nt
  s_add_u32 s60, s60, s73
  s_waitcnt vmcnt(47)
  v_dot2_f32_bf16 v40, v80, v14, 0
  v_dot2_f32_bf16 v40, v81, v15, v40
  v_dot2_f32_bf16 v40, v82, v16, v40
  v_dot2_f32_bf16 v40, v83, v17, v40
  buffer_load_dwordx4 v[80:83], v2, s[8:11], s60 offen offset:0 nt
  s_waitcnt vmcnt(47)
  v_dot2_f32_bf16 v41, v84, v14, 0
  v_dot2_f32_bf16 v41, v85, v15, v41
  v_dot2_f32_bf16 v41, v86, v16, v41
  v_dot2_f32_bf16 v41, v87, v17, v41
  buffer_load_dwordx4 v[84:87], v2, s[8:11], s60 offen offset:1024 nt
  s_waitcnt vmcnt(47)
  v_dot2_f32_bf16 v42, v88, v14, 0
  v_dot2_f32_bf16 v42, v89, v15, v42
  v_dot2_f32_bf16 v42, v90, v16, v42
  v_dot2_f32_bf16 v42, v91, v17, v42
  buffer_load_dwordx4 v[88:91], v2, s[8:11], s60 offen offset:2048 nt
  s_waitcnt vmcnt(47)
  v_dot2_f32_bf16 v43, v92, v14, 0
  v_dot2_f32_bf16 v43, v93, v15, v43
  v_dot2_f32_bf16 v43, v94, v16, v43
  v_dot2_f32_bf16 v43, v95, v17, v43
  buffer_load_dwordx4 v[92:95], v2, s[8:11], s60 offen offset:3072 nt
  s_add_u32 s60, s60, s73
  s_waitcnt vmcnt(47)
  v_dot2_f32_bf16 v44, v96, v14, 0
  v_dot2_f32_bf16 v44, v97, v15, v44
  v_dot2_f32_bf16 v44, v98, v16, v44
  v_dot2_f32_bf16 v44, v99, v17, v44
  buffer_load_dwordx4 v[96:99], v2, s[8:11], s60 offen offset:0 nt
  s_waitcnt vmcnt(47)
  v_dot2_f32_bf16 v45, v100, v14, 0
  v_dot2_f32_bf16 v45, v101, v15, v45
  v_dot2_f32_bf16 v45, v102, v16, v45
  v_dot2_f32_bf16 v45, v103, v17, v45
  buffer_load_dwordx4 v[100:103], v2, s[8:11], s60 offen offset:1024 nt
  s_waitcnt vmcnt(47)
  v_dot2_f32_bf16 v46, v104, v14, 0
  v_dot2_f32_bf16 v46, v105, v15, v46
  v_dot2_f32_bf16 v46, v106, v16, v46
  v_dot2_f32_bf16 v46, v107, v17, v46
  buffer_load_dwordx4 v[104:107], v2, s[8:11], s60 offen offset:2048 nt
  s_waitcnt vmcnt(47)
  v_dot2_f32_bf16 v47, v108, v14, 0
  v_dot2_f32_bf16 v47, v109, v15, v47
  v_dot2_f32_bf16 v47, v110, v16, v47
  v_dot2_f32_bf16 v47, v111, v17, v47
  buffer_load_dwordx4 v[108:111], v2, s[8:11], s60 offen offset:3072 nt
  s_add_u32 s60, s60, s73
  s_waitcnt vmcnt(47)
  v_dot2_f32_bf16 v48, v112, v14, 0
  v_dot2_f32_bf16 v48, v113, v15, v48
  v_dot2_f32_bf16 v48, v114, v16, v48
  v_dot2_f32_bf16 v48, v115, v17, v48
  buffer_load_dwordx4 v[112:115], v2, s[8:11], s60 offen offset:0 nt
  s_waitcnt vmcnt(47)
  v_dot2_f32_bf16 v49, v116, v14, 0
  v_dot2_f32_bf16 v49, v117, v15, v49
  v_dot2_f32_bf16 v49, v118, v16, v49
  v_dot2_f32_bf16 v49, v119, v17, v49
  buffer_load_dwordx4 v[116:119], v2, s[8:11], s60 offen offset:1024 nt
  s_waitcnt vmcnt(47)
  v_dot2_f32_bf16 v50, v120, v14, 0
  v_dot2_f32_bf16 v50, v121, v15, v50
  v_dot2_f32_bf16 v50, v122, v16, v50
  v_dot2_f32_bf16 v50, v123, v17, v50
  buffer_load_dwordx4 v[120:123], v2, s[8:11], s60 offen offset:2048 nt
  s_waitcnt vmcnt(47)
  v_dot2_f32_bf16 v51, v124, v14, 0
  v_dot2_f32_bf16 v51, v125, v15, v51
  v_dot2_f32_bf16 v51, v126, v16, v51
  v_dot2_f32_bf16 v51, v127, v17, v51
  buffer_load_dwordx4 v[124:127], v2, s[8:11], s60 offen offset:3072 nt
  s_add_u32 s60, s60, s73
  v_add_f32_dpp v36, v36, v36 row_ror:8 row_mask:0xf bank_mask:0x3
  s_nop 1
  v_add_f32_dpp v36, v44, v44 row_ror:8 row_mask:0xf bank_mask:0xc
  v_add_f32_dpp v37, v37, v37 row_ror:8 row_mask:0xf bank_mask:0x3
  s_nop 1
  v_add_f32_dpp v37, v45, v45 row_ror:8 row_mask:0xf bank_mask:0xc
  v_add_f32_dpp v38, v38, v38 row_ror:8 row_mask:0xf bank_mask:0x3
  s_nop 1
  v_add_f32_dpp v38, v46, v46 row_ror:8 row_mask:0xf bank_mask:0xc
  v_add_f32_dpp v39, v39, v39 row_ror:8 row_mask:0xf bank_mask:0x3
  s_nop 1
  v_add_f32_dpp v39, v47, v47 row_ror:8 row_mask:0xf bank_mask:0xc
  v_add_f32_dpp v40, v40, v40 row_ror:8 row_mask:0xf bank_mask:0x3
  s_nop 1
  v_add_f32_dpp v40, v48, v48 row_ror:8 row_mask:0xf bank_mask:0xc
  v_add_f32_dpp v41, v41, v41 row_ror:8 row_mask:0xf bank_mask:0x3
  s_nop 1
  v_add_f32_dpp v41, v49, v49 row_ror:8 row_mask:0xf bank_mask:0xc
  v_add_f32_dpp v42, v42, v42 row_ror:8 row_mask:0xf bank_mask:0x3
  s_nop 1
  v_add_f32_dpp v42, v50, v50 row_ror:8 row_mask:0xf bank_mask:0xc
  v_add_f32_dpp v43, v43, v43 row_ror:8 row_mask:0xf bank_mask:0x3
  s_nop 1
  v_add_f32_dpp v43, v51, v51 row_ror:8 row_mask:0xf bank_mask:0xc
  v_add_f32_dpp v36, v36, v36 row_shl:4 row_mask:0xf bank_mask:0x5
  s_nop 1
  v_add_f32_dpp v36, v40, v40 row_shr:4 row_mask:0xf bank_mask:0xa
  v_add_f32_dpp v37, v37, v37 row_shl:4 row_mask:0xf bank_mask:0x5
  s_nop 1
  v_add_f32_dpp v37, v41, v41 row_shr:4 row_mask:0xf bank_mask:0xa
  v_add_f32_dpp v38, v38, v38 row_shl:4 row_mask:0xf bank_mask:0x5
  s_nop 1
  v_add_f32_dpp v38, v42, v42 row_shr:4 row_mask:0xf bank_mask:0xa
  v_add_f32_dpp v39, v39, v39 row_shl:4 row_mask:0xf bank_mask:0x5
  s_nop 1
  v_add_f32_dpp v39, v43, v43 row_shr:4 row_mask:0xf bank_mask:0xa
  v_cndmask_b32 v40, v38, v36, s[32:33]
  v_cndmask_b32 v41, v39, v37, s[32:33]
  v_cndmask_b32 v42, v36, v38, s[32:33]
  v_cndmask_b32 v43, v37, v39, s[32:33]
  s_nop 0
  v_add_f32_dpp v42, v40, v42 quad_perm:[2,3,0,1] row_mask:0xf bank_mask:0xf
  v_add_f32_dpp v43, v41, v43 quad_perm:[2,3,0,1] row_mask:0xf bank_mask:0xf
  v_cndmask_b32 v40, v43, v42, s[34:35]
  v_cndmask_b32 v41, v42, v43, s[34:35]
  s_nop 1
  v_add_f32_dpp v41, v40, v41 quad_perm:[1,0,3,2] row_mask:0xf bank_mask:0xf
  v_cvt_pk_bf16_f32 v41, v41, v41
  v_lshlrev_b32 v41, 16, v41
  v_mul_f32 v41, s81, v41
  v_cvt_pk_bf16_f32 v41, v41, v41
  v_lshlrev_b32 v41, 16, v41
  v_mul_f32 v41, s80, v41
  ds_write_b32 v3, v41
  v_add_u32 v3, 256, v3
  v_max_f32 v9, v9, v41
  s_cmp_eq_u32 s61, 19
  s_cbranch_scc1 L1_kend
  s_cmp_eq_u32 s61, 16
  s_cselect_b32 s8, s40, s8
  s_cselect_b32 s9, s41, s9
  s_cselect_b32 s60, s85, s60
  s_add_u32 s61, s61, 1
  s_waitcnt vmcnt(47)
  v_dot2_f32_bf16 v36, v128, v14, 0
  v_dot2_f32_bf16 v36, v129, v15, v36
  v_dot2_f32_bf16 v36, v130, v16, v36
  v_dot2_f32_bf16 v36, v131, v17, v36
  buffer_load_dwordx4 v[128:131], v2, s[8:11], s60 offen offset:0 nt
  s_waitcnt vmcnt(47)
  v_dot2_f32_bf16 v37, v132, v14, 0
  v_dot2_f32_bf16 v37, v133, v15, v37
  v_dot2_f32_bf16 v37, v134, v16, v37
  v_dot2_f32_bf16 v37, v135, v17, v37
  buffer_load_dwordx4 v[132:135], v2, s[8:11], s60 offen offset:1024 nt
  s_waitcnt vmcnt(47)
  v_dot2_f32_bf16 v38, v136, v14, 0
  v_dot2_f32_bf16 v38, v137, v15, v38
  v_dot2_f32_bf16 v38, v138, v16, v38
  v_dot2_f32_bf16 v38, v139, v17, v38
  buffer_load_dwordx4 v[136:139], v2, s[8:11], s60 offen offset:2048 nt
  s_waitcnt vmcnt(47)
  v_dot2_f32_bf16 v39, v140, v14, 0
  v_dot2_f32_bf16 v39, v141, v15, v39
  v_dot2_f32_bf16 v39, v142, v16, v39
  v_dot2_f32_bf16 v39, v143, v17, v39
  buffer_load_dwordx4 v[140:143], v2, s[8:11], s60 offen offset:3072 nt
  s_add_u32 s60, s60, s73
  s_waitcnt vmcnt(47)
  v_dot2_f32_bf16 v40, v144, v14, 0
  v_dot2_f32_bf16 v40, v145, v15, v40
  v_dot2_f32_bf16 v40, v146, v16, v40
  v_dot2_f32_bf16 v40, v147, v17, v40
  buffer_load_dwordx4 v[144:147], v2, s[8:11], s60 offen offset:0 nt
  s_waitcnt vmcnt(47)
  v_dot2_f32_bf16 v41, v148, v14, 0
  v_dot2_f32_bf16 v41, v149, v15, v41
  v_dot2_f32_bf16 v41, v150, v16, v41
  v_dot2_f32_bf16 v41, v151, v17, v41
  buffer_load_dwordx4 v[148:151], v2, s[8:11], s60 offen offset:1024 nt
  s_waitcnt vmcnt(47)
  v_dot2_f32_bf16 v42, v152, v14, 0
  v_dot2_f32_bf16 v42, v153, v15, v42
  v_dot2_f32_bf16 v42, v154, v16, v42
  v_dot2_f32_bf16 v42, v155, v17, v42
  buffer_load_dwordx4 v[152:155], v2, s[8:11], s60 offen offset:2048 nt
  s_waitcnt vmcnt(47)
  v_dot2_f32_bf16 v43, v156, v14, 0
  v_dot2_f32_bf16 v43, v157, v15, v43
  v_dot2_f32_bf16 v43, v158, v16, v43
  v_dot2_f32_bf16 v43, v159, v17, v43
  buffer_load_dwordx4 v[156:159], v2, s[8:11], s60 offen offset:3072 nt
  s_add_u32 s60, s60, s73
  s_waitcnt vmcnt(47)
  v_dot2_f32_bf16 v44, v160, v14, 0
  v_dot2_f32_bf16 v44, v161, v15, v44
  v_dot2_f32_bf16 v44, v162, v16, v44
  v_dot2_f32_bf16 v44, v163, v17, v44
  buffer_load_dwordx4 v[160:163], v2, s[8:11], s60 offen offset:0 nt
  s_waitcnt vmcnt(47)
  v_dot2_f32_bf16 v45, v164, v14, 0
  v_dot2_f32_bf16 v45, v165, v15, v45
  v_dot2_f32_bf16 v45, v166, v16, v45
  v_dot2_f32_bf16 v45, v167, v17, v45
  buffer_load_dwordx4 v[164:167], v2, s[8:11], s60 offen offset:1024 nt
  s_waitcnt vmcnt(47)
  v_dot2_f32_bf16 v46, v168, v14, 0
  v_dot2_f32_bf16 v46, v169, v15, v46
  v_dot2_f32_bf16 v46, v170, v16, v46
  v_dot2_f32_bf16 v46, v171, v17, v46
  buffer_load_dwordx4 v[168:171], v2, s[8:11], s60 offen offset:2048 nt
  s_waitcnt vmcnt(47)
  v_dot2_f32_bf16 v47, v172, v14, 0
  v_dot2_f32_bf16 v47, v173, v15, v47
  v_dot2_f32_bf16 v47, v174, v16, v47
  v_dot2_f32_bf16 v47, v175, v17, v47
  buffer_load_dwordx4 v[172:175], v2, s[8:11], s60 offen offset:3072 nt
  s_add_u32 s60, s60, s73
  s_waitcnt vmcnt(47)
  v_dot2_f32_bf16 v48, v176, v14, 0
  v_dot2_f32_bf16 v48, v177, v15, v48
  v_dot2_f32_bf16 v48, v178, v16, v48
  v_dot2_f32_bf16 v48, v179, v17, v48
  buffer_load_dwordx4 v[176:179], v2, s[8:11], s60 offen offset:0 nt
  s_waitcnt vmcnt(47)
  v_dot2_f32_bf16 v49, v180, v14, 0
  v_dot2_f32_bf16 v49, v181, v15, v49
  v_dot2_f32_bf16 v49, v182, v16, v49
  v_dot2_f32_bf16 v49, v183, v17, v49
  buffer_load_dwordx4 v[180:183], v2, s[8:11], s60 offen offset:1024 nt
  s_waitcnt vmcnt(47)
  v_dot2_f32_bf16 v50, v184, v14, 0
  v_dot2_f32_bf16 v50, v185, v15, v50
  v_dot2_f32_bf16 v50, v186, v16, v50
  v_dot2_f32_bf16 v50, v187, v17, v50
  buffer_load_dwordx4 v[184:187], v2, s[8:11], s60 offen offset:2048 nt
  s_waitcnt vmcnt(47)
  v_dot2_f32_bf16 v51, v188, v14, 0
  v_dot2_f32_bf16 v51, v189, v15, v51
  v_dot2_f32_bf16 v51, v190, v16, v51
  v_dot2_f32_bf16 v51, v191, v17, v51
  buffer_load_dwordx4 v[188:191], v2, s[8:11], s60 offen offset:3072 nt
  s_add_u32 s60, s60, s73
  v_add_f32_dpp v36, v36, v36 row_ror:8 row_mask:0xf bank_mask:0x3
  s_nop 1
  v_add_f32_dpp v36, v44, v44 row_ror:8 row_mask:0xf bank_mask:0xc
  v_add_f32_dpp v37, v37, v37 row_ror:8 row_mask:0xf bank_mask:0x3
  s_nop 1
  v_add_f32_dpp v37, v45, v45 row_ror:8 row_mask:0xf bank_mask:0xc
  v_add_f32_dpp v38, v38, v38 row_ror:8 row_mask:0xf bank_mask:0x3
  s_nop 1
  v_add_f32_dpp v38, v46, v46 row_ror:8 row_mask:0xf bank_mask:0xc
  v_add_f32_dpp v39, v39, v39 row_ror:8 row_mask:0xf bank_mask:0x3
  s_nop 1
  v_add_f32_dpp v39, v47, v47 row_ror:8 row_mask:0xf bank_mask:0xc
  v_add_f32_dpp v40, v40, v40 row_ror:8 row_mask:0xf bank_mask:0x3
  s_nop 1
  v_add_f32_dpp v40, v48, v48 row_ror:8 row_mask:0xf bank_mask:0xc
  v_add_f32_dpp v41, v41, v41 row_ror:8 row_mask:0xf bank_mask:0x3
  s_nop 1
  v_add_f32_dpp v41, v49, v49 row_ror:8 row_mask:0xf bank_mask:0xc
  v_add_f32_dpp v42, v42, v42 row_ror:8 row_mask:0xf bank_mask:0x3
  s_nop 1
  v_add_f32_dpp v42, v50, v50 row_ror:8 row_mask:0xf bank_mask:0xc
  v_add_f32_dpp v43, v43, v43 row_ror:8 row_mask:0xf bank_mask:0x3
  s_nop 1
  v_add_f32_dpp v43, v51, v51 row_ror:8 row_mask:0xf bank_mask:0xc
  v_add_f32_dpp v36, v36, v36 row_shl:4 row_mask:0xf bank_mask:0x5
  s_nop 1
  v_add_f32_dpp v36, v40, v40 row_shr:4 row_mask:0xf bank_mask:0xa
  v_add_f32_dpp v37, v37, v37 row_shl:4 row_mask:0xf bank_mask:0x5
  s_nop 1
  v_add_f32_dpp v37, v41, v41 row_shr:4 row_mask:0xf bank_mask:0xa
  v_add_f32_dpp v38, v38, v38 row_shl:4 row_mask:0xf bank_mask:0x5
  s_nop 1
  v_add_f32_dpp v38, v42, v42 row_shr:4 row_mask:0xf bank_mask:0xa
  v_add_f32_dpp v39, v39, v39 row_shl:4 row_mask:0xf bank_mask:0x5
  s_nop 1
  v_add_f32_dpp v39, v43, v43 row_shr:4 row_mask:0xf bank_mask:0xa
  v_cndmask_b32 v40, v38, v36, s[32:33]
  v_cndmask_b32 v41, v39, v37, s[32:33]
  v_cndmask_b32 v42, v36, v38, s[32:33]
  v_cndmask_b32 v43, v37, v39, s[32:33]
  s_nop 0
  v_add_f32_dpp v42, v40, v42 quad_perm:[2,3,0,1] row_mask:0xf bank_mask:0xf
  v_add_f32_dpp v43, v41, v43 quad_perm:[2,3,0,1] row_mask:0xf bank_mask:0xf
  v_cndmask_b32 v40, v43, v42, s[34:35]
  v_cndmask_b32 v41, v42, v43, s[34:35]
  s_nop 1
  v_add_f32_dpp v41, v40, v41 quad_perm:[1,0,3,2] row_mask:0xf bank_mask:0xf
  v_cvt_pk_bf16_f32 v41, v41, v41
  v_lshlrev_b32 v41, 16, v41
  v_mul_f32 v41, s81, v41
  v_cvt_pk_bf16_f32 v41, v41, v41
  v_lshlrev_b32 v41, 16, v41
  v_mul_f32 v41, s80, v41
  ds_write_b32 v3, v41
  v_add_u32 v3, 256, v3
  v_max_f32 v9, v9, v41
  s_cmp_eq_u32 s61, 19
  s_cbranch_scc1 L1_kend
  s_cmp_eq_u32 s61, 16
  s_cselect_b32 s8, s40, s8
  s_cselect_b32 s9, s41, s9
  s_cselect_b32 s60, s85, s60
  s_add_u32 s61, s61, 1
  s_waitcnt vmcnt(47)
  v_dot2_f32_bf16 v36, v192, v14, 0
  v_dot2_f32_bf16 v36, v193, v15, v36
  v_dot2_f32_bf16 v36, v194, v16, v36
  v_dot2_f32_bf16 v36, v195, v17, v36
  buffer_load_dwordx4 v[192:195], v2, s[8:11], s60 offen offset:0 nt
  s_waitcnt vmcnt(47)
  v_dot2_f32_bf16 v37, v196, v14, 0
  v_dot2_f32_bf16 v37, v197, v15, v37
  v_dot2_f32_bf16 v37, v198, v16, v37
  v_dot2_f32_bf16 v37, v199, v17, v37
  buffer_load_dwordx4 v[196:199], v2, s[8:11], s60 offen offset:1024 nt
  s_waitcnt vmcnt(47)
  v_dot2_f32_bf16 v38, v200, v14, 0
  v_dot2_f32_bf16 v38, v201, v15, v38
  v_dot2_f32_bf16 v38, v202, v16, v38
  v_dot2_f32_bf16 v38, v203, v17, v38
  buffer_load_dwordx4 v[200:203], v2, s[8:11], s60 offen offset:2048 nt
  s_waitcnt vmcnt(47)
  v_dot2_f32_bf16 v39, v204, v14, 0
  v_dot2_f32_bf16 v39, v205, v15, v39
  v_dot2_f32_bf16 v39, v206, v16, v39
  v_dot2_f32_bf16 v39, v207, v17, v39
  buffer_load_dwordx4 v[204:207], v2, s[8:11], s60 offen offset:3072 nt
  s_add_u32 s60, s60, s73
  s_waitcnt vmcnt(47)
  v_dot2_f32_bf16 v40, v208, v14, 0
  v_dot2_f32_bf16 v40, v209, v15, v40
  v_dot2_f32_bf16 v40, v210, v16, v40
  v_dot2_f32_bf16 v40, v211, v17, v40
  buffer_load_dwordx4 v[208:211], v2, s[8:11], s60 offen offset:0 nt
  s_waitcnt vmcnt(47)
  v_dot2_f32_bf16 v41, v212, v14, 0
  v_dot2_f32_bf16 v41, v213, v15, v41
  v_dot2_f32_bf16 v41, v214, v16, v41
  v_dot2_f32_bf16 v41, v215, v17, v41
  buffer_load_dwordx4 v[212:215], v2, s[8:11], s60 offen offset:1024 nt
  s_waitcnt vmcnt(47)
  v_dot2_f32_bf16 v42, v216, v14, 0
  v_dot2_f32_bf16 v42, v217, v15, v42
  v_dot2_f32_bf16 v42, v218, v16, v42
  v_dot2_f32_bf16 v42, v219, v17, v42
  buffer_load_dwordx4 v[216:219], v2, s[8:11], s60 offen offset:2048 nt
  s_waitcnt vmcnt(47)
  v_dot2_f32_bf16 v43, v220, v14, 0
  v_dot2_f32_bf16 v43, v221, v15, v43
  v_dot2_f32_bf16 v43, v222, v16, v43
  v_dot2_f32_bf16 v43, v223, v17, v43
  buffer_load_dwordx4 v[220:223], v2, s[8:11], s60 offen offset:3072 nt
  s_add_u32 s60, s60, s73
  s_waitcnt vmcnt(47)
  v_dot2_f32_bf16 v44, v224, v14, 0
  v_dot2_f32_bf16 v44, v225, v15, v44
  v_dot2_f32_bf16 v44, v226, v16, v44
  v_dot2_f32_bf16 v44, v227, v17, v44
  buffer_load_dwordx4 v[224:227], v2, s[8:11], s60 offen offset:0 nt
  s_waitcnt vmcnt(47)
  v_dot2_f32_bf16 v45, v228, v14, 0
  v_dot2_f32_bf16 v45, v229, v15, v45
  v_dot2_f32_bf16 v45, v230, v16, v45
  v_dot2_f32_bf16 v45, v231, v17, v45
  buffer_load_dwordx4 v[228:231], v2, s[8:11], s60 offen offset:1024 nt
  s_waitcnt vmcnt(47)
  v_dot2_f32_bf16 v46, v232, v14, 0
  v_dot2_f32_bf16 v46, v233, v15, v46
  v_dot2_f32_bf16 v46, v234, v16, v46
  v_dot2_f32_bf16 v46, v235, v17, v46
  buffer_load_dwordx4 v[232:235], v2, s[8:11], s60 offen offset:2048 nt
  s_waitcnt vmcnt(47)
  v_dot2_f32_bf16 v47, v236, v14, 0
  v_dot2_f32_bf16 v47, v237, v15, v47
  v_dot2_f32_bf16 v47, v238, v16, v47
  v_dot2_f32_bf16 v47, v239, v17, v47
  buffer_load_dwordx4 v[236:239], v2, s[8:11], s60 offen offset:3072 nt
  s_add_u32 s60, s60, s73
  s_waitcnt vmcnt(47)
  v_dot2_f32_bf16 v48, v240, v14, 0
  v_dot2_f32_bf16 v48, v241, v15, v48
  v_dot2_f32_bf16 v48, v242, v16, v48
  v_dot2_f32_bf16 v48, v243, v17, v48
  buffer_load_dwordx4 v[240:243], v2, s[8:11], s60 offen offset:0 nt
  s_waitcnt vmcnt(47)
  v_dot2_f32_bf16 v49, v244, v14, 0
  v_dot2_f32_bf16 v49, v245, v15, v49
  v_dot2_f32_bf16 v49, v246, v16, v49
  v_dot2_f32_bf16 v49, v247, v17, v49
  buffer_load_dwordx4 v[244:247], v2, s[8:11], s60 offen offset:1024 nt
  s_waitcnt vmcnt(47)
  v_dot2_f32_bf16 v50, v248, v14, 0
  v_dot2_f32_bf16 v50, v249, v15, v50
  v_dot2_f32_bf16 v50, v250, v16, v50
  v_dot2_f32_bf16 v50, v251, v17, v50
  buffer_load_dwordx4 v[248:251], v2, s[8:11], s60 offen offset:2048 nt
  s_waitcnt vmcnt(47)
  v_dot2_f32_bf16 v51, v252, v14, 0
  v_dot2_f32_bf16 v51, v253, v15, v51
  v_dot2_f32_bf16 v51, v254, v16, v51
  v_dot2_f32_bf16 v51, v255, v17, v51
  buffer_load_dwordx4 v[252:255], v2, s[8:11], s60 offen offset:3072 nt
  s_add_u32 s60, s60, s73
  v_add_f32_dpp v36, v36, v36 row_ror:8 row_mask:0xf bank_mask:0x3
  s_nop 1
  v_add_f32_dpp v36, v44, v44 row_ror:8 row_mask:0xf bank_mask:0xc
  v_add_f32_dpp v37, v37, v37 row_ror:8 row_mask:0xf bank_mask:0x3
  s_nop 1
  v_add_f32_dpp v37, v45, v45 row_ror:8 row_mask:0xf bank_mask:0xc
  v_add_f32_dpp v38, v38, v38 row_ror:8 row_mask:0xf bank_mask:0x3
  s_nop 1
  v_add_f32_dpp v38, v46, v46 row_ror:8 row_mask:0xf bank_mask:0xc
  v_add_f32_dpp v39, v39, v39 row_ror:8 row_mask:0xf bank_mask:0x3
  s_nop 1
  v_add_f32_dpp v39, v47, v47 row_ror:8 row_mask:0xf bank_mask:0xc
  v_add_f32_dpp v40, v40, v40 row_ror:8 row_mask:0xf bank_mask:0x3
  s_nop 1
  v_add_f32_dpp v40, v48, v48 row_ror:8 row_mask:0xf bank_mask:0xc
  v_add_f32_dpp v41, v41, v41 row_ror:8 row_mask:0xf bank_mask:0x3
  s_nop 1
  v_add_f32_dpp v41, v49, v49 row_ror:8 row_mask:0xf bank_mask:0xc
  v_add_f32_dpp v42, v42, v42 row_ror:8 row_mask:0xf bank_mask:0x3
  s_nop 1
  v_add_f32_dpp v42, v50, v50 row_ror:8 row_mask:0xf bank_mask:0xc
  v_add_f32_dpp v43, v43, v43 row_ror:8 row_mask:0xf bank_mask:0x3
  s_nop 1
  v_add_f32_dpp v43, v51, v51 row_ror:8 row_mask:0xf bank_mask:0xc
  v_add_f32_dpp v36, v36, v36 row_shl:4 row_mask:0xf bank_mask:0x5
  s_nop 1
  v_add_f32_dpp v36, v40, v40 row_shr:4 row_mask:0xf bank_mask:0xa
  v_add_f32_dpp v37, v37, v37 row_shl:4 row_mask:0xf bank_mask:0x5
  s_nop 1
  v_add_f32_dpp v37, v41, v41 row_shr:4 row_mask:0xf bank_mask:0xa
  v_add_f32_dpp v38, v38, v38 row_shl:4 row_mask:0xf bank_mask:0x5
  s_nop 1
  v_add_f32_dpp v38, v42, v42 row_shr:4 row_mask:0xf bank_mask:0xa
  v_add_f32_dpp v39, v39, v39 row_shl:4 row_mask:0xf bank_mask:0x5
  s_nop 1
  v_add_f32_dpp v39, v43, v43 row_shr:4 row_mask:0xf bank_mask:0xa
  v_cndmask_b32 v40, v38, v36, s[32:33]
  v_cndmask_b32 v41, v39, v37, s[32:33]
  v_cndmask_b32 v42, v36, v38, s[32:33]
  v_cndmask_b32 v43, v37, v39, s[32:33]
  s_nop 0
  v_add_f32_dpp v42, v40, v42 quad_perm:[2,3,0,1] row_mask:0xf bank_mask:0xf
  v_add_f32_dpp v43, v41, v43 quad_perm:[2,3,0,1] row_mask:0xf bank_mask:0xf
  v_cndmask_b32 v40, v43, v42, s[34:35]
  v_cndmask_b32 v41, v42, v43, s[34:35]
  s_nop 1
  v_add_f32_dpp v41, v40, v41 quad_perm:[1,0,3,2] row_mask:0xf bank_mask:0xf
  v_cvt_pk_bf16_f32 v41, v41, v41
  v_lshlrev_b32 v41, 16, v41
  v_mul_f32 v41, s81, v41
  v_cvt_pk_bf16_f32 v41, v41, v41
  v_lshlrev_b32 v41, 16, v41
  v_mul_f32 v41, s80, v41
  ds_write_b32 v3, v41
  v_add_u32 v3, 256, v3
  v_max_f32 v9, v9, v41
  s_cmp_eq_u32 s61, 19
  s_cbranch_scc0 L1_kloop
L1_kend:
  s_nop 4
  ds_read_b32 v11, v4
  v_max_f32_dpp v9, v9, v9 row_ror:8 row_mask:0xf bank_mask:0xf
  s_nop 1
  v_max_f32_dpp v9, v9, v9 row_ror:4 row_mask:0xf bank_mask:0xf
  s_nop 1
  v_max_f32_dpp v9, v9, v9 row_ror:2 row_mask:0xf bank_mask:0xf
  s_nop 1
  v_max_f32_dpp v9, v9, v9 row_ror:1 row_mask:0xf bank_mask:0xf
  v_mov_b32 v61, v9
  s_nop 1
  v_permlane16_swap_b32 v9, v61
  v_max_f32 v9, v9, v61
  v_mov_b32 v61, v9
  s_nop 1
  v_permlane32_swap_b32 v9, v61
  v_max_f32 v9, v9, v61
  s_branch L1_v1
L1_v0:
  s_nop 4
  s_cmp_eq_u32 s61, 32
  s_cselect_b32 s10, 0, s10
  s_add_u32 s61, s61, 1
  s_waitcnt lgkmcnt(0)
  v_sub_f32 v61, v11, v9
  v_add_u32 v4, 256, v4
  v_exp_f32 v61, v61
  ds_read_b32 v11, v4
  v_add_f32 v10, v10, v61
  v_mov_b32_dpp v12, v61 row_newbcast:0 row_mask:0xf bank_mask:0xf
  s_waitcnt vmcnt(47)
  v_lshlrev_b32 v28, 16, v64
  v_and_b32 v29, s31, v64
  v_lshlrev_b32 v30, 16, v65
  v_and_b32 v31, s31, v65
  v_lshlrev_b32 v32, 16, v66
  v_and_b32 v33, s31, v66
  v_lshlrev_b32 v34, 16, v67
  v_and_b32 v35, s31, v67
  buffer_load_dwordx4 v[64:67], v2, s[8:11], s60 offen offset:0 nt
  v_pk_fma_f32 v[20:21], v[28:29], v[12:13], v[20:21] op_sel_hi:[1,0,1]
  v_pk_fma_f32 v[22:23], v[30:31], v[12:13], v[22:23] op_sel_hi:[1,0,1]
  v_pk_fma_f32 v[24:25], v[32:33], v[12:13], v[24:25] op_sel_hi:[1,0,1]
  v_pk_fma_f32 v[26:27], v[34:35], v[12:13], v[26:27] op_sel_hi:[1,0,1]
  v_mov_b32_dpp v12, v61 row_newbcast:1 row_mask:0xf bank_mask:0xf
  s_waitcnt vmcnt(47)
  v_lshlrev_b32 v28, 16, v68
  v_and_b32 v29, s31, v68
  v_lshlrev_b32 v30, 16, v69
  v_and_b32 v31, s31, v69
  v_lshlrev_b32 v32, 16, v70
  v_and_b32 v33, s31, v70
  v_lshlrev_b32 v34, 16, v71
  v_and_b32 v35, s31, v71
  buffer_load_dwordx4 v[68:71], v2, s[8:11], s60 offen offset:1024 nt
  v_pk_fma_f32 v[20:21], v[28:29], v[12:13], v[20:21] op_sel_hi:[1,0,1]
  v_pk_fma_f32 v[22:23], v[30:31], v[12:13], v[22:23] op_sel_hi:[1,0,1]
  v_pk_fma_f32 v[24:25], v[32:33], v[12:13], v[24:25] op_sel_hi:[1,0,1]
  v_pk_fma_f32 v[26:27], v[34:35], v[12:13], v[26:27] op_sel_hi:[1,0,1]
  v_mov_b32_dpp v12, v61 row_newbcast:2 row_mask:0xf bank_mask:0xf
  s_waitcnt vmcnt(47)
  v_lshlrev_b32 v28, 16, v72
  v_and_b32 v29, s31, v72
  v_lshlrev_b32 v30, 16, v73
  v_and_b32 v31, s31, v73
  v_lshlrev_b32 v32, 16, v74
  v_and_b32 v33, s31, v74
  v_lshlrev_b32 v34, 16, v75
  v_and_b32 v35, s31, v75
  buffer_load_dwordx4 v[72:75], v2, s[8:11], s60 offen offset:2048 nt
  v_pk_fma_f32 v[20:21], v[28:29], v[12:13], v[20:21] op_sel_hi:[1,0,1]
  v_pk_fma_f32 v[22:23], v[30:31], v[12:13], v[22:23] op_sel_hi:[1,0,1]
  v_pk_fma_f32 v[24:25], v[32:33], v[12:13], v[24:25] op_sel_hi:[1,0,1]
  v_pk_fma_f32 v[26:27], v[34:35], v[12:13], v[26:27] op_sel_hi:[1,0,1]
  v_mov_b32_dpp v12, v61 row_newbcast:3 row_mask:0xf bank_mask:0xf
  s_waitcnt vmcnt(47)
  v_lshlrev_b32 v28, 16, v76
  v_and_b32 v29, s31, v76
  v_lshlrev_b32 v30, 16, v77
  v_and_b32 v31, s31, v77
  v_lshlrev_b32 v32, 16, v78
  v_and_b32 v33, s31, v78
  v_lshlrev_b32 v34, 16, v79
  v_and_b32 v35, s31, v79
  buffer_load_dwordx4 v[76:79], v2, s[8:11], s60 offen offset:3072 nt
  s_add_u32 s60, s60, s73
  v_pk_fma_f32 v[20:21], v[28:29], v[12:13], v[20:21] op_sel_hi:[1,0,1]
  v_pk_fma_f32 v[22:23], v[30:31], v[12:13], v[22:23] op_sel_hi:[1,0,1]
  v_pk_fma_f32 v[24:25], v[32:33], v[12:13], v[24:25] op_sel_hi:[1,0,1]
  v_pk_fma_f32 v[26:27], v[34:35], v[12:13], v[26:27] op_sel_hi:[1,0,1]
  v_mov_b32_dpp v12, v61 row_newbcast:4 row_mask:0xf bank_mask:0xf
  s_waitcnt vmcnt(47)
  v_lshlrev_b32 v28, 16, v80
  v_and_b32 v29, s31, v80
  v_lshlrev_b32 v30, 16, v81
  v_and_b32 v31, s31, v81
  v_lshlrev_b32 v32, 16, v82
  v_and_b32 v33, s31, v82
  v_lshlrev_b32 v34, 16, v83
  v_and_b32 v35, s31, v83
  buffer_load_dwordx4 v[80:83], v2, s[8:11], s60 offen offset:0 nt
  v_pk_fma_f32 v[20:21], v[28:29], v[12:13], v[20:21] op_sel_hi:[1,0,1]
  v_pk_fma_f32 v[22:23], v[30:31], v[12:13], v[22:23] op_sel_hi:[1,0,1]
  v_pk_fma_f32 v[24:25], v[32:33], v[12:13], v[24:25] op_sel_hi:[1,0,1]
  v_pk_fma_f32 v[26:27], v[34:35], v[12:13], v[26:27] op_sel_hi:[1,0,1]
  v_mov_b32_dpp v12, v61 row_newbcast:5 row_mask:0xf bank_mask:0xf
  s_waitcnt vmcnt(47)
  v_lshlrev_b32 v28, 16, v84
  v_and_b32 v29, s31, v84
  v_lshlrev_b32 v30, 16, v85
  v_and_b32 v31, s31, v85
  v_lshlrev_b32 v32, 16, v86
  v_and_b32 v33, s31, v86
  v_lshlrev_b32 v34, 16, v87
  v_and_b32 v35, s31, v87
  buffer_load_dwordx4 v[84:87], v2, s[8:11], s60 offen offset:1024 nt
  v_pk_fma_f32 v[20:21], v[28:29], v[12:13], v[20:21] op_sel_hi:[1,0,1]
  v_pk_fma_f32 v[22:23], v[30:31], v[12:13], v[22:23] op_sel_hi:[1,0,1]
  v_pk_fma_f32 v[24:25], v[32:33], v[12:13], v[24:25] op_sel_hi:[1,0,1]
  v_pk_fma_f32 v[26:27], v[34:35], v[12:13], v[26:27] op_sel_hi:[1,0,1]
  v_mov_b32_dpp v12, v61 row_newbcast:6 row_mask:0xf bank_mask:0xf
  s_waitcnt vmcnt(47)
  v_lshlrev_b32 v28, 16, v88
  v_and_b32 v29, s31, v88
  v_lshlrev_b32 v30, 16, v89
  v_and_b32 v31, s31, v89
  v_lshlrev_b32 v32, 16, v90
  v_and_b32 v33, s31, v90
  v_lshlrev_b32 v34, 16, v91
  v_and_b32 v35, s31, v91
  buffer_load_dwordx4 v[88:91], v2, s[8:11], s60 offen offset:2048 nt
  v_pk_fma_f32 v[20:21], v[28:29], v[12:13], v[20:21] op_sel_hi:[1,0,1]
  v_pk_fma_f32 v[22:23], v[30:31], v[12:13], v[22:23] op_sel_hi:[1,0,1]
  v_pk_fma_f32 v[24:25], v[32:33], v[12:13], v[24:25] op_sel_hi:[1,0,1]
  v_pk_fma_f32 v[26:27], v[34:35], v[12:13], v[26:27] op_sel_hi:[1,0,1]
  v_mov_b32_dpp v12, v61 row_newbcast:7 row_mask:0xf bank_mask:0xf
  s_waitcnt vmcnt(47)
  v_lshlrev_b32 v28, 16, v92
  v_and_b32 v29, s31, v92
  v_lshlrev_b32 v30, 16, v93
  v_and_b32 v31, s31, v93
  v_lshlrev_b32 v32, 16, v94
  v_and_b32 v33, s31, v94
  v_lshlrev_b32 v34, 16, v95
  v_and_b32 v35, s31, v95
  buffer_load_dwordx4 v[92:95], v2, s[8:11], s60 offen offset:3072 nt
  s_add_u32 s60, s60, s73
  v_pk_fma_f32 v[20:21], v[28:29], v[12:13], v[20:21] op_sel_hi:[1,0,1]
  v_pk_fma_f32 v[22:23], v[30:31], v[12:13], v[22:23] op_sel_hi:[1,0,1]
  v_pk_fma_f32 v[24:25], v[32:33], v[12:13], v[24:25] op_sel_hi:[1,0,1]
  v_pk_fma_f32 v[26:27], v[34:35], v[12:13], v[26:27] op_sel_hi:[1,0,1]
  v_mov_b32_dpp v12, v61 row_newbcast:8 row_mask:0xf bank_mask:0xf
  s_waitcnt vmcnt(47)
  v_lshlrev_b32 v28, 16, v96
  v_and_b32 v29, s31, v96
  v_lshlrev_b32 v30, 16, v97
  v_and_b32 v31, s31, v97
  v_lshlrev_b32 v32, 16, v98
  v_and_b32 v33, s31, v98
  v_lshlrev_b32 v34, 16, v99
  v_and_b32 v35, s31, v99
  buffer_load_dwordx4 v[96:99], v2, s[8:11], s60 offen offset:0 nt
  v_pk_fma_f32 v[20:21], v[28:29], v[12:13], v[20:21] op_sel_hi:[1,0,1]
  v_pk_fma_f32 v[22:23], v[30:31], v[12:13], v[22:23] op_sel_hi:[1,0,1]
  v_pk_fma_f32 v[24:25], v[32:33], v[12:13], v[24:25] op_sel_hi:[1,0,1]
  v_pk_fma_f32 v[26:27], v[34:35], v[12:13], v[26:27] op_sel_hi:[1,0,1]
  v_mov_b32_dpp v12, v61 row_newbcast:9 row_mask:0xf bank_mask:0xf
  s_waitcnt vmcnt(47)
  v_lshlrev_b32 v28, 16, v100
  v_and_b32 v29, s31, v100
  v_lshlrev_b32 v30, 16, v101
  v_and_b32 v31, s31, v101
  v_lshlrev_b32 v32, 16, v102
  v_and_b32 v33, s31, v102
  v_lshlrev_b32 v34, 16, v103
  v_and_b32 v35, s31, v103
  buffer_load_dwordx4 v[100:103], v2, s[8:11], s60 offen offset:1024 nt
  v_pk_fma_f32 v[20:21], v[28:29], v[12:13], v[20:21] op_sel_hi:[1,0,1]
  v_pk_fma_f32 v[22:23], v[30:31], v[12:13], v[22:23] op_sel_hi:[1,0,1]
  v_pk_fma_f32 v[24:25], v[32:33], v[12:13], v[24:25] op_sel_hi:[1,0,1]
  v_pk_fma_f32 v[26:27], v[34:35], v[12:13], v[26:27] op_sel_hi:[1,0,1]
  v_mov_b32_dpp v12, v61 row_newbcast:10 row_mask:0xf bank_mask:0xf
  s_waitcnt vmcnt(47)
  v_lshlrev_b32 v28, 16, v104
  v_and_b32 v29, s31, v104
  v_lshlrev_b32 v30, 16, v105
  v_and_b32 v31, s31, v105
  v_lshlrev_b32 v32, 16, v106
  v_and_b32 v33, s31, v106
  v_lshlrev_b32 v34, 16, v107
  v_and_b32 v35, s31, v107
  buffer_load_dwordx4 v[104:107], v2, s[8:11], s60 offen offset:2048 nt
  v_pk_fma_f32 v[20:21], v[28:29], v[12:13], v[20:21] op_sel_hi:[1,0,1]
  v_pk_fma_f32 v[22:23], v[30:31], v[12:13], v[22:23] op_sel_hi:[1,0,1]
  v_pk_fma_f32 v[24:25], v[32:33], v[12:13], v[24:25] op_sel_hi:[1,0,1]
  v_pk_fma_f32 v[26:27], v[34:35], v[12:13], v[26:27] op_sel_hi:[1,0,1]
  v_mov_b32_dpp v12, v61 row_newbcast:11 row_mask:0xf bank_mask:0xf
  s_waitcnt vmcnt(47)
  v_lshlrev_b32 v28, 16, v108
  v_and_b32 v29, s31, v108
  v_lshlrev_b32 v30, 16, v109
  v_and_b32 v31, s31, v109
  v_lshlrev_b32 v32, 16, v110
  v_and_b32 v33, s31, v110
  v_lshlrev_b32 v34, 16, v111
  v_and_b32 v35, s31, v111
  buffer_load_dwordx4 v[108:111], v2, s[8:11], s60 offen offset:3072 nt
  s_add_u32 s60, s60, s73
  v_pk_fma_f32 v[20:21], v[28:29], v[12:13], v[20:21] op_sel_hi:[1,0,1]
  v_pk_fma_f32 v[22:23], v[30:31], v[12:13], v[22:23] op_sel_hi:[1,0,1]
  v_pk_fma_f32 v[24:25], v[32:33], v[12:13], v[24:25] op_sel_hi:[1,0,1]
  v_pk_fma_f32 v[26:27], v[34:35], v[12:13], v[26:27] op_sel_hi:[1,0,1]
  v_mov_b32_dpp v12, v61 row_newbcast:12 row_mask:0xf bank_mask:0xf
  s_waitcnt vmcnt(47)
  v_lshlrev_b32 v28, 16, v112
  v_and_b32 v29, s31, v112
  v_lshlrev_b32 v30, 16, v113
  v_and_b32 v31, s31, v113
  v_lshlrev_b32 v32, 16, v114
  v_and_b32 v33, s31, v114
  v_lshlrev_b32 v34, 16, v115
  v_and_b32 v35, s31, v115
  buffer_load_dwordx4 v[112:115], v2, s[8:11], s60 offen offset:0 nt
  v_pk_fma_f32 v[20:21], v[28:29], v[12:13], v[20:21] op_sel_hi:[1,0,1]
  v_pk_fma_f32 v[22:23], v[30:31], v[12:13], v[22:23] op_sel_hi:[1,0,1]
  v_pk_fma_f32 v[24:25], v[32:33], v[12:13], v[24:25] op_sel_hi:[1,0,1]
  v_pk_fma_f32 v[26:27], v[34:35], v[12:13], v[26:27] op_sel_hi:[1,0,1]
  v_mov_b32_dpp v12, v61 row_newbcast:13 row_mask:0xf bank_mask:0xf
  s_waitcnt vmcnt(47)
  v_lshlrev_b32 v28, 16, v116
  v_and_b32 v29, s31, v116
  v_lshlrev_b32 v30, 16, v117
  v_and_b32 v31, s31, v117
  v_lshlrev_b32 v32, 16, v118
  v_and_b32 v33, s31, v118
  v_lshlrev_b32 v34, 16, v119
  v_and_b32 v35, s31, v119
  buffer_load_dwordx4 v[116:119], v2, s[8:11], s60 offen offset:1024 nt
  v_pk_fma_f32 v[20:21], v[28:29], v[12:13], v[20:21] op_sel_hi:[1,0,1]
  v_pk_fma_f32 v[22:23], v[30:31], v[12:13], v[22:23] op_sel_hi:[1,0,1]
  v_pk_fma_f32 v[24:25], v[32:33], v[12:13], v[24:25] op_sel_hi:[1,0,1]
  v_pk_fma_f32 v[26:27], v[34:35], v[12:13], v[26:27] op_sel_hi:[1,0,1]
  v_mov_b32_dpp v12, v61 row_newbcast:14 row_mask:0xf bank_mask:0xf
  s_waitcnt vmcnt(47)
  v_lshlrev_b32 v28, 16, v120
  v_and_b32 v29, s31, v120
  v_lshlrev_b32 v30, 16, v121
  v_and_b32 v31, s31, v121
  v_lshlrev_b32 v32, 16, v122
  v_and_b32 v33, s31, v122
  v_lshlrev_b32 v34, 16, v123
  v_and_b32 v35, s31, v123
  buffer_load_dwordx4 v[120:123], v2, s[8:11], s60 offen offset:2048 nt
  v_pk_fma_f32 v[20:21], v[28:29], v[12:13], v[20:21] op_sel_hi:[1,0,1]
  v_pk_fma_f32 v[22:23], v[30:31], v[12:13], v[22:23] op_sel_hi:[1,0,1]
  v_pk_fma_f32 v[24:25], v[32:33], v[12:13], v[24:25] op_sel_hi:[1,0,1]
  v_pk_fma_f32 v[26:27], v[34:35], v[12:13], v[26:27] op_sel_hi:[1,0,1]
  v_mov_b32_dpp v12, v61 row_newbcast:15 row_mask:0xf bank_mask:0xf
  s_waitcnt vmcnt(47)
  v_lshlrev_b32 v28, 16, v124
  v_and_b32 v29, s31, v124
  v_lshlrev_b32 v30, 16, v125
  v_and_b32 v31, s31, v125
  v_lshlrev_b32 v32, 16, v126
  v_and_b32 v33, s31, v126
  v_lshlrev_b32 v34, 16, v127
  v_and_b32 v35, s31, v127
  buffer_load_dwordx4 v[124:127], v2, s[8:11], s60 offen offset:3072 nt
  s_add_u32 s60, s60, s73
  v_pk_fma_f32 v[20:21], v[28:29], v[12:13], v[20:21] op_sel_hi:[1,0,1]
  v_pk_fma_f32 v[22:23], v[30:31], v[12:13], v[22:23] op_sel_hi:[1,0,1]
  v_pk_fma_f32 v[24:25], v[32:33], v[12:13], v[24:25] op_sel_hi:[1,0,1]
  v_pk_fma_f32 v[26:27], v[34:35], v[12:13], v[26:27] op_sel_hi:[1,0,1]
  s_cmp_eq_u32 s61, 35
  s_cbranch_scc1 L1_send
L1_v1:
  s_nop 4
  s_cmp_eq_u32 s61, 32
  s_cselect_b32 s10, 0, s10
  s_add_u32 s61, s61, 1
  s_waitcnt lgkmcnt(0)
  v_sub_f32 v61, v11, v9
  v_add_u32 v4, 256, v4
  v_exp_f32 v61, v61
  ds_read_b32 v11, v4
  v_add_f32 v10, v10, v61
  v_mov_b32_dpp v12, v61 row_newbcast:0 row_mask:0xf bank_mask:0xf
  s_waitcnt vmcnt(47)
  v_lshlrev_b32 v28, 16, v128
  v_and_b32 v29, s31, v128
  v_lshlrev_b32 v30, 16, v129
  v_and_b32 v31, s31, v129
  v_lshlrev_b32 v32, 16, v130
  v_and_b32 v33, s31, v130
  v_lshlrev_b32 v34, 16, v131
  v_and_b32 v35, s31, v131
  buffer_load_dwordx4 v[128:131], v2, s[8:11], s60 offen offset:0 nt
  v_pk_fma_f32 v[20:21], v[28:29], v[12:13], v[20:21] op_sel_hi:[1,0,1]
  v_pk_fma_f32 v[22:23], v[30:31], v[12:13], v[22:23] op_sel_hi:[1,0,1]
  v_pk_fma_f32 v[24:25], v[32:33], v[12:13], v[24:25] op_sel_hi:[1,0,1]
  v_pk_fma_f32 v[26:27], v[34:35], v[12:13], v[26:27] op_sel_hi:[1,0,1]
  v_mov_b32_dpp v12, v61 row_newbcast:1 row_mask:0xf bank_mask:0xf
  s_waitcnt vmcnt(47)
  v_lshlrev_b32 v28, 16, v132
  v_and_b32 v29, s31, v132
  v_lshlrev_b32 v30, 16, v133
  v_and_b32 v31, s31, v133
  v_lshlrev_b32 v32, 16, v134
  v_and_b32 v33, s31, v134
  v_lshlrev_b32 v34, 16, v135
  v_and_b32 v35, s31, v135
  buffer_load_dwordx4 v[132:135], v2, s[8:11], s60 offen offset:1024 nt
  v_pk_fma_f32 v[20:21], v[28:29], v[12:13], v[20:21] op_sel_hi:[1,0,1]
  v_pk_fma_f32 v[22:23], v[30:31], v[12:13], v[22:23] op_sel_hi:[1,0,1]
  v_pk_fma_f32 v[24:25], v[32:33], v[12:13], v[24:25] op_sel_hi:[1,0,1]
  v_pk_fma_f32 v[26:27], v[34:35], v[12:13], v[26:27] op_sel_hi:[1,0,1]
  v_mov_b32_dpp v12, v61 row_newbcast:2 row_mask:0xf bank_mask:0xf
  s_waitcnt vmcnt(47)
  v_lshlrev_b32 v28, 16, v136
  v_and_b32 v29, s31, v136
  v_lshlrev_b32 v30, 16, v137
  v_and_b32 v31, s31, v137
  v_lshlrev_b32 v32, 16, v138
  v_and_b32 v33, s31, v138
  v_lshlrev_b32 v34, 16, v139
  v_and_b32 v35, s31, v139
  buffer_load_dwordx4 v[136:139], v2, s[8:11], s60 offen offset:2048 nt
  v_pk_fma_f32 v[20:21], v[28:29], v[12:13], v[20:21] op_sel_hi:[1,0,1]
  v_pk_fma_f32 v[22:23], v[30:31], v[12:13], v[22:23] op_sel_hi:[1,0,1]
  v_pk_fma_f32 v[24:25], v[32:33], v[12:13], v[24:25] op_sel_hi:[1,0,1]
  v_pk_fma_f32 v[26:27], v[34:35], v[12:13], v[26:27] op_sel_hi:[1,0,1]
  v_mov_b32_dpp v12, v61 row_newbcast:3 row_mask:0xf bank_mask:0xf
  s_waitcnt vmcnt(47)
  v_lshlrev_b32 v28, 16, v140
  v_and_b32 v29, s31, v140
  v_lshlrev_b32 v30, 16, v141
  v_and_b32 v31, s31, v141
  v_lshlrev_b32 v32, 16, v142
  v_and_b32 v33, s31, v142
  v_lshlrev_b32 v34, 16, v143
  v_and_b32 v35, s31, v143
  buffer_load_dwordx4 v[140:143], v2, s[8:11], s60 offen offset:3072 nt
  s_add_u32 s60, s60, s73
  v_pk_fma_f32 v[20:21], v[28:29], v[12:13], v[20:21] op_sel_hi:[1,0,1]
  v_pk_fma_f32 v[22:23], v[30:31], v[12:13], v[22:23] op_sel_hi:[1,0,1]
  v_pk_fma_f32 v[24:25], v[32:33], v[12:13], v[24:25] op_sel_hi:[1,0,1]
  v_pk_fma_f32 v[26:27], v[34:35], v[12:13], v[26:27] op_sel_hi:[1,0,1]
  v_mov_b32_dpp v12, v61 row_newbcast:4 row_mask:0xf bank_mask:0xf
  s_waitcnt vmcnt(47)
  v_lshlrev_b32 v28, 16, v144
  v_and_b32 v29, s31, v144
  v_lshlrev_b32 v30, 16, v145
  v_and_b32 v31, s31, v145
  v_lshlrev_b32 v32, 16, v146
  v_and_b32 v33, s31, v146
  v_lshlrev_b32 v34, 16, v147
  v_and_b32 v35, s31, v147
  buffer_load_dwordx4 v[144:147], v2, s[8:11], s60 offen offset:0 nt
  v_pk_fma_f32 v[20:21], v[28:29], v[12:13], v[20:21] op_sel_hi:[1,0,1]
  v_pk_fma_f32 v[22:23], v[30:31], v[12:13], v[22:23] op_sel_hi:[1,0,1]
  v_pk_fma_f32 v[24:25], v[32:33], v[12:13], v[24:25] op_sel_hi:[1,0,1]
  v_pk_fma_f32 v[26:27], v[34:35], v[12:13], v[26:27] op_sel_hi:[1,0,1]
  v_mov_b32_dpp v12, v61 row_newbcast:5 row_mask:0xf bank_mask:0xf
  s_waitcnt vmcnt(47)
  v_lshlrev_b32 v28, 16, v148
  v_and_b32 v29, s31, v148
  v_lshlrev_b32 v30, 16, v149
  v_and_b32 v31, s31, v149
  v_lshlrev_b32 v32, 16, v150
  v_and_b32 v33, s31, v150
  v_lshlrev_b32 v34, 16, v151
  v_and_b32 v35, s31, v151
  buffer_load_dwordx4 v[148:151], v2, s[8:11], s60 offen offset:1024 nt
  v_pk_fma_f32 v[20:21], v[28:29], v[12:13], v[20:21] op_sel_hi:[1,0,1]
  v_pk_fma_f32 v[22:23], v[30:31], v[12:13], v[22:23] op_sel_hi:[1,0,1]
  v_pk_fma_f32 v[24:25], v[32:33], v[12:13], v[24:25] op_sel_hi:[1,0,1]
  v_pk_fma_f32 v[26:27], v[34:35], v[12:13], v[26:27] op_sel_hi:[1,0,1]
  v_mov_b32_dpp v12, v61 row_newbcast:6 row_mask:0xf bank_mask:0xf
  s_waitcnt vmcnt(47)
  v_lshlrev_b32 v28, 16, v152
  v_and_b32 v29, s31, v152
  v_lshlrev_b32 v30, 16, v153
  v_and_b32 v31, s31, v153
  v_lshlrev_b32 v32, 16, v154
  v_and_b32 v33, s31, v154
  v_lshlrev_b32 v34, 16, v155
  v_and_b32 v35, s31, v155
  buffer_load_dwordx4 v[152:155], v2, s[8:11], s60 offen offset:2048 nt
  v_pk_fma_f32 v[20:21], v[28:29], v[12:13], v[20:21] op_sel_hi:[1,0,1]
  v_pk_fma_f32 v[22:23], v[30:31], v[12:13], v[22:23] op_sel_hi:[1,0,1]
  v_pk_fma_f32 v[24:25], v[32:33], v[12:13], v[24:25] op_sel_hi:[1,0,1]
  v_pk_fma_f32 v[26:27], v[34:35], v[12:13], v[26:27] op_sel_hi:[1,0,1]
  v_mov_b32_dpp v12, v61 row_newbcast:7 row_mask:0xf bank_mask:0xf
  s_waitcnt vmcnt(47)
  v_lshlrev_b32 v28, 16, v156
  v_and_b32 v29, s31, v156
  v_lshlrev_b32 v30, 16, v157
  v_and_b32 v31, s31, v157
  v_lshlrev_b32 v32, 16, v158
  v_and_b32 v33, s31, v158
  v_lshlrev_b32 v34, 16, v159
  v_and_b32 v35, s31, v159
  buffer_load_dwordx4 v[156:159], v2, s[8:11], s60 offen offset:3072 nt
  s_add_u32 s60, s60, s73
  v_pk_fma_f32 v[20:21], v[28:29], v[12:13], v[20:21] op_sel_hi:[1,0,1]
  v_pk_fma_f32 v[22:23], v[30:31], v[12:13], v[22:23] op_sel_hi:[1,0,1]
  v_pk_fma_f32 v[24:25], v[32:33], v[12:13], v[24:25] op_sel_hi:[1,0,1]
  v_pk_fma_f32 v[26:27], v[34:35], v[12:13], v[26:27] op_sel_hi:[1,0,1]
  v_mov_b32_dpp v12, v61 row_newbcast:8 row_mask:0xf bank_mask:0xf
  s_waitcnt vmcnt(47)
  v_lshlrev_b32 v28, 16, v160
  v_and_b32 v29, s31, v160
  v_lshlrev_b32 v30, 16, v161
  v_and_b32 v31, s31, v161
  v_lshlrev_b32 v32, 16, v162
  v_and_b32 v33, s31, v162
  v_lshlrev_b32 v34, 16, v163
  v_and_b32 v35, s31, v163
  buffer_load_dwordx4 v[160:163], v2, s[8:11], s60 offen offset:0 nt
  v_pk_fma_f32 v[20:21], v[28:29], v[12:13], v[20:21] op_sel_hi:[1,0,1]
  v_pk_fma_f32 v[22:23], v[30:31], v[12:13], v[22:23] op_sel_hi:[1,0,1]
  v_pk_fma_f32 v[24:25], v[32:33], v[12:13], v[24:25] op_sel_hi:[1,0,1]
  v_pk_fma_f32 v[26:27], v[34:35], v[12:13], v[26:27] op_sel_hi:[1,0,1]
  v_mov_b32_dpp v12, v61 row_newbcast:9 row_mask:0xf bank_mask:0xf
  s_waitcnt vmcnt(47)
  v_lshlrev_b32 v28, 16, v164
  v_and_b32 v29, s31, v164
  v_lshlrev_b32 v30, 16, v165
  v_and_b32 v31, s31, v165
  v_lshlrev_b32 v32, 16, v166
  v_and_b32 v33, s31, v166
  v_lshlrev_b32 v34, 16, v167
  v_and_b32 v35, s31, v167
  buffer_load_dwordx4 v[164:167], v2, s[8:11], s60 offen offset:1024 nt
  v_pk_fma_f32 v[20:21], v[28:29], v[12:13], v[20:21] op_sel_hi:[1,0,1]
  v_pk_fma_f32 v[22:23], v[30:31], v[12:13], v[22:23] op_sel_hi:[1,0,1]
  v_pk_fma_f32 v[24:25], v[32:33], v[12:13], v[24:25] op_sel_hi:[1,0,1]
  v_pk_fma_f32 v[26:27], v[34:35], v[12:13], v[26:27] op_sel_hi:[1,0,1]
  v_mov_b32_dpp v12, v61 row_newbcast:10 row_mask:0xf bank_mask:0xf
  s_waitcnt vmcnt(47)
  v_lshlrev_b32 v28, 16, v168
  v_and_b32 v29, s31, v168
  v_lshlrev_b32 v30, 16, v169
  v_and_b32 v31, s31, v169
  v_lshlrev_b32 v32, 16, v170
  v_and_b32 v33, s31, v170
  v_lshlrev_b32 v34, 16, v171
  v_and_b32 v35, s31, v171
  buffer_load_dwordx4 v[168:171], v2, s[8:11], s60 offen offset:2048 nt
  v_pk_fma_f32 v[20:21], v[28:29], v[12:13], v[20:21] op_sel_hi:[1,0,1]
  v_pk_fma_f32 v[22:23], v[30:31], v[12:13], v[22:23] op_sel_hi:[1,0,1]
  v_pk_fma_f32 v[24:25], v[32:33], v[12:13], v[24:25] op_sel_hi:[1,0,1]
  v_pk_fma_f32 v[26:27], v[34:35], v[12:13], v[26:27] op_sel_hi:[1,0,1]
  v_mov_b32_dpp v12, v61 row_newbcast:11 row_mask:0xf bank_mask:0xf
  s_waitcnt vmcnt(47)
  v_lshlrev_b32 v28, 16, v172
  v_and_b32 v29, s31, v172
  v_lshlrev_b32 v30, 16, v173
  v_and_b32 v31, s31, v173
  v_lshlrev_b32 v32, 16, v174
  v_and_b32 v33, s31, v174
  v_lshlrev_b32 v34, 16, v175
  v_and_b32 v35, s31, v175
  buffer_load_dwordx4 v[172:175], v2, s[8:11], s60 offen offset:3072 nt
  s_add_u32 s60, s60, s73
  v_pk_fma_f32 v[20:21], v[28:29], v[12:13], v[20:21] op_sel_hi:[1,0,1]
  v_pk_fma_f32 v[22:23], v[30:31], v[12:13], v[22:23] op_sel_hi:[1,0,1]
  v_pk_fma_f32 v[24:25], v[32:33], v[12:13], v[24:25] op_sel_hi:[1,0,1]
  v_pk_fma_f32 v[26:27], v[34:35], v[12:13], v[26:27] op_sel_hi:[1,0,1]
  v_mov_b32_dpp v12, v61 row_newbcast:12 row_mask:0xf bank_mask:0xf
  s_waitcnt vmcnt(47)
  v_lshlrev_b32 v28, 16, v176
  v_and_b32 v29, s31, v176
  v_lshlrev_b32 v30, 16, v177
  v_and_b32 v31, s31, v177
  v_lshlrev_b32 v32, 16, v178
  v_and_b32 v33, s31, v178
  v_lshlrev_b32 v34, 16, v179
  v_and_b32 v35, s31, v179
  buffer_load_dwordx4 v[176:179], v2, s[8:11], s60 offen offset:0 nt
  v_pk_fma_f32 v[20:21], v[28:29], v[12:13], v[20:21] op_sel_hi:[1,0,1]
  v_pk_fma_f32 v[22:23], v[30:31], v[12:13], v[22:23] op_sel_hi:[1,0,1]
  v_pk_fma_f32 v[24:25], v[32:33], v[12:13], v[24:25] op_sel_hi:[1,0,1]
  v_pk_fma_f32 v[26:27], v[34:35], v[12:13], v[26:27] op_sel_hi:[1,0,1]
  v_mov_b32_dpp v12, v61 row_newbcast:13 row_mask:0xf bank_mask:0xf
  s_waitcnt vmcnt(47)
  v_lshlrev_b32 v28, 16, v180
  v_and_b32 v29, s31, v180
  v_lshlrev_b32 v30, 16, v181
  v_and_b32 v31, s31, v181
  v_lshlrev_b32 v32, 16, v182
  v_and_b32 v33, s31, v182
  v_lshlrev_b32 v34, 16, v183
  v_and_b32 v35, s31, v183
  buffer_load_dwordx4 v[180:183], v2, s[8:11], s60 offen offset:1024 nt
  v_pk_fma_f32 v[20:21], v[28:29], v[12:13], v[20:21] op_sel_hi:[1,0,1]
  v_pk_fma_f32 v[22:23], v[30:31], v[12:13], v[22:23] op_sel_hi:[1,0,1]
  v_pk_fma_f32 v[24:25], v[32:33], v[12:13], v[24:25] op_sel_hi:[1,0,1]
  v_pk_fma_f32 v[26:27], v[34:35], v[12:13], v[26:27] op_sel_hi:[1,0,1]
  v_mov_b32_dpp v12, v61 row_newbcast:14 row_mask:0xf bank_mask:0xf
  s_waitcnt vmcnt(47)
  v_lshlrev_b32 v28, 16, v184
  v_and_b32 v29, s31, v184
  v_lshlrev_b32 v30, 16, v185
  v_and_b32 v31, s31, v185
  v_lshlrev_b32 v32, 16, v186
  v_and_b32 v33, s31, v186
  v_lshlrev_b32 v34, 16, v187
  v_and_b32 v35, s31, v187
  buffer_load_dwordx4 v[184:187], v2, s[8:11], s60 offen offset:2048 nt
  v_pk_fma_f32 v[20:21], v[28:29], v[12:13], v[20:21] op_sel_hi:[1,0,1]
  v_pk_fma_f32 v[22:23], v[30:31], v[12:13], v[22:23] op_sel_hi:[1,0,1]
  v_pk_fma_f32 v[24:25], v[32:33], v[12:13], v[24:25] op_sel_hi:[1,0,1]
  v_pk_fma_f32 v[26:27], v[34:35], v[12:13], v[26:27] op_sel_hi:[1,0,1]
  v_mov_b32_dpp v12, v61 row_newbcast:15 row_mask:0xf bank_mask:0xf
  s_waitcnt vmcnt(47)
  v_lshlrev_b32 v28, 16, v188
  v_and_b32 v29, s31, v188
  v_lshlrev_b32 v30, 16, v189
  v_and_b32 v31, s31, v189
  v_lshlrev_b32 v32, 16, v190
  v_and_b32 v33, s31, v190
  v_lshlrev_b32 v34, 16, v191
  v_and_b32 v35, s31, v191
  buffer_load_dwordx4 v[188:191], v2, s[8:11], s60 offen offset:3072 nt
  s_add_u32 s60, s60, s73
  v_pk_fma_f32 v[20:21], v[28:29], v[12:13], v[20:21] op_sel_hi:[1,0,1]
  v_pk_fma_f32 v[22:23], v[30:31], v[12:13], v[22:23] op_sel_hi:[1,0,1]
  v_pk_fma_f32 v[24:25], v[32:33], v[12:13], v[24:25] op_sel_hi:[1,0,1]
  v_pk_fma_f32 v[26:27], v[34:35], v[12:13], v[26:27] op_sel_hi:[1,0,1]
  s_cmp_eq_u32 s61, 35
  s_cbranch_scc1 L1_send
L1_v2:
  s_nop 4
  s_cmp_eq_u32 s61, 32
  s_cselect_b32 s10, 0, s10
  s_add_u32 s61, s61, 1
  s_waitcnt lgkmcnt(0)
  v_sub_f32 v61, v11, v9
  v_add_u32 v4, 256, v4
  v_exp_f32 v61, v61
  ds_read_b32 v11, v4
  v_add_f32 v10, v10, v61
  v_mov_b32_dpp v12, v61 row_newbcast:0 row_mask:0xf bank_mask:0xf
  s_waitcnt vmcnt(47)
  v_lshlrev_b32 v28, 16, v192
  v_and_b32 v29, s31, v192
  v_lshlrev_b32 v30, 16, v193
  v_and_b32 v31, s31, v193
  v_lshlrev_b32 v32, 16, v194
  v_and_b32 v33, s31, v194
  v_lshlrev_b32 v34, 16, v195
  v_and_b32 v35, s31, v195
  buffer_load_dwordx4 v[192:195], v2, s[8:11], s60 offen offset:0 nt
  v_pk_fma_f32 v[20:21], v[28:29], v[12:13], v[20:21] op_sel_hi:[1,0,1]
  v_pk_fma_f32 v[22:23], v[30:31], v[12:13], v[22:23] op_sel_hi:[1,0,1]
  v_pk_fma_f32 v[24:25], v[32:33], v[12:13], v[24:25] op_sel_hi:[1,0,1]
  v_pk_fma_f32 v[26:27], v[34:35], v[12:13], v[26:27] op_sel_hi:[1,0,1]
  v_mov_b32_dpp v12, v61 row_newbcast:1 row_mask:0xf bank_mask:0xf
  s_waitcnt vmcnt(47)
  v_lshlrev_b32 v28, 16, v196
  v_and_b32 v29, s31, v196
  v_lshlrev_b32 v30, 16, v197
  v_and_b32 v31, s31, v197
  v_lshlrev_b32 v32, 16, v198
  v_and_b32 v33, s31, v198
  v_lshlrev_b32 v34, 16, v199
  v_and_b32 v35, s31, v199
  buffer_load_dwordx4 v[196:199], v2, s[8:11], s60 offen offset:1024 nt
  v_pk_fma_f32 v[20:21], v[28:29], v[12:13], v[20:21] op_sel_hi:[1,0,1]
  v_pk_fma_f32 v[22:23], v[30:31], v[12:13], v[22:23] op_sel_hi:[1,0,1]
  v_pk_fma_f32 v[24:25], v[32:33], v[12:13], v[24:25] op_sel_hi:[1,0,1]
  v_pk_fma_f32 v[26:27], v[34:35], v[12:13], v[26:27] op_sel_hi:[1,0,1]
  v_mov_b32_dpp v12, v61 row_newbcast:2 row_mask:0xf bank_mask:0xf
  s_waitcnt vmcnt(47)
  v_lshlrev_b32 v28, 16, v200
  v_and_b32 v29, s31, v200
  v_lshlrev_b32 v30, 16, v201
  v_and_b32 v31, s31, v201
  v_lshlrev_b32 v32, 16, v202
  v_and_b32 v33, s31, v202
  v_lshlrev_b32 v34, 16, v203
  v_and_b32 v35, s31, v203
  buffer_load_dwordx4 v[200:203], v2, s[8:11], s60 offen offset:2048 nt
  v_pk_fma_f32 v[20:21], v[28:29], v[12:13], v[20:21] op_sel_hi:[1,0,1]
  v_pk_fma_f32 v[22:23], v[30:31], v[12:13], v[22:23] op_sel_hi:[1,0,1]
  v_pk_fma_f32 v[24:25], v[32:33], v[12:13], v[24:25] op_sel_hi:[1,0,1]
  v_pk_fma_f32 v[26:27], v[34:35], v[12:13], v[26:27] op_sel_hi:[1,0,1]
  v_mov_b32_dpp v12, v61 row_newbcast:3 row_mask:0xf bank_mask:0xf
  s_waitcnt vmcnt(47)
  v_lshlrev_b32 v28, 16, v204
  v_and_b32 v29, s31, v204
  v_lshlrev_b32 v30, 16, v205
  v_and_b32 v31, s31, v205
  v_lshlrev_b32 v32, 16, v206
  v_and_b32 v33, s31, v206
  v_lshlrev_b32 v34, 16, v207
  v_and_b32 v35, s31, v207
  buffer_load_dwordx4 v[204:207], v2, s[8:11], s60 offen offset:3072 nt
  s_add_u32 s60, s60, s73
  v_pk_fma_f32 v[20:21], v[28:29], v[12:13], v[20:21] op_sel_hi:[1,0,1]
  v_pk_fma_f32 v[22:23], v[30:31], v[12:13], v[22:23] op_sel_hi:[1,0,1]
  v_pk_fma_f32 v[24:25], v[32:33], v[12:13], v[24:25] op_sel_hi:[1,0,1]
  v_pk_fma_f32 v[26:27], v[34:35], v[12:13], v[26:27] op_sel_hi:[1,0,1]
  v_mov_b32_dpp v12, v61 row_newbcast:4 row_mask:0xf bank_mask:0xf
  s_waitcnt vmcnt(47)
  v_lshlrev_b32 v28, 16, v208
  v_and_b32 v29, s31, v208
  v_lshlrev_b32 v30, 16, v209
  v_and_b32 v31, s31, v209
  v_lshlrev_b32 v32, 16, v210
  v_and_b32 v33, s31, v210
  v_lshlrev_b32 v34, 16, v211
  v_and_b32 v35, s31, v211
  buffer_load_dwordx4 v[208:211], v2, s[8:11], s60 offen offset:0 nt
  v_pk_fma_f32 v[20:21], v[28:29], v[12:13], v[20:21] op_sel_hi:[1,0,1]
  v_pk_fma_f32 v[22:23], v[30:31], v[12:13], v[22:23] op_sel_hi:[1,0,1]
  v_pk_fma_f32 v[24:25], v[32:33], v[12:13], v[24:25] op_sel_hi:[1,0,1]
  v_pk_fma_f32 v[26:27], v[34:35], v[12:13], v[26:27] op_sel_hi:[1,0,1]
  v_mov_b32_dpp v12, v61 row_newbcast:5 row_mask:0xf bank_mask:0xf
  s_waitcnt vmcnt(47)
  v_lshlrev_b32 v28, 16, v212
  v_and_b32 v29, s31, v212
  v_lshlrev_b32 v30, 16, v213
  v_and_b32 v31, s31, v213
  v_lshlrev_b32 v32, 16, v214
  v_and_b32 v33, s31, v214
  v_lshlrev_b32 v34, 16, v215
  v_and_b32 v35, s31, v215
  buffer_load_dwordx4 v[212:215], v2, s[8:11], s60 offen offset:1024 nt
  v_pk_fma_f32 v[20:21], v[28:29], v[12:13], v[20:21] op_sel_hi:[1,0,1]
  v_pk_fma_f32 v[22:23], v[30:31], v[12:13], v[22:23] op_sel_hi:[1,0,1]
  v_pk_fma_f32 v[24:25], v[32:33], v[12:13], v[24:25] op_sel_hi:[1,0,1]
  v_pk_fma_f32 v[26:27], v[34:35], v[12:13], v[26:27] op_sel_hi:[1,0,1]
  v_mov_b32_dpp v12, v61 row_newbcast:6 row_mask:0xf bank_mask:0xf
  s_waitcnt vmcnt(47)
  v_lshlrev_b32 v28, 16, v216
  v_and_b32 v29, s31, v216
  v_lshlrev_b32 v30, 16, v217
  v_and_b32 v31, s31, v217
  v_lshlrev_b32 v32, 16, v218
  v_and_b32 v33, s31, v218
  v_lshlrev_b32 v34, 16, v219
  v_and_b32 v35, s31, v219
  buffer_load_dwordx4 v[216:219], v2, s[8:11], s60 offen offset:2048 nt
  v_pk_fma_f32 v[20:21], v[28:29], v[12:13], v[20:21] op_sel_hi:[1,0,1]
  v_pk_fma_f32 v[22:23], v[30:31], v[12:13], v[22:23] op_sel_hi:[1,0,1]
  v_pk_fma_f32 v[24:25], v[32:33], v[12:13], v[24:25] op_sel_hi:[1,0,1]
  v_pk_fma_f32 v[26:27], v[34:35], v[12:13], v[26:27] op_sel_hi:[1,0,1]
  v_mov_b32_dpp v12, v61 row_newbcast:7 row_mask:0xf bank_mask:0xf
  s_waitcnt vmcnt(47)
  v_lshlrev_b32 v28, 16, v220
  v_and_b32 v29, s31, v220
  v_lshlrev_b32 v30, 16, v221
  v_and_b32 v31, s31, v221
  v_lshlrev_b32 v32, 16, v222
  v_and_b32 v33, s31, v222
  v_lshlrev_b32 v34, 16, v223
  v_and_b32 v35, s31, v223
  buffer_load_dwordx4 v[220:223], v2, s[8:11], s60 offen offset:3072 nt
  s_add_u32 s60, s60, s73
  v_pk_fma_f32 v[20:21], v[28:29], v[12:13], v[20:21] op_sel_hi:[1,0,1]
  v_pk_fma_f32 v[22:23], v[30:31], v[12:13], v[22:23] op_sel_hi:[1,0,1]
  v_pk_fma_f32 v[24:25], v[32:33], v[12:13], v[24:25] op_sel_hi:[1,0,1]
  v_pk_fma_f32 v[26:27], v[34:35], v[12:13], v[26:27] op_sel_hi:[1,0,1]
  v_mov_b32_dpp v12, v61 row_newbcast:8 row_mask:0xf bank_mask:0xf
  s_waitcnt vmcnt(47)
  v_lshlrev_b32 v28, 16, v224
  v_and_b32 v29, s31, v224
  v_lshlrev_b32 v30, 16, v225
  v_and_b32 v31, s31, v225
  v_lshlrev_b32 v32, 16, v226
  v_and_b32 v33, s31, v226
  v_lshlrev_b32 v34, 16, v227
  v_and_b32 v35, s31, v227
  buffer_load_dwordx4 v[224:227], v2, s[8:11], s60 offen offset:0 nt
  v_pk_fma_f32 v[20:21], v[28:29], v[12:13], v[20:21] op_sel_hi:[1,0,1]
  v_pk_fma_f32 v[22:23], v[30:31], v[12:13], v[22:23] op_sel_hi:[1,0,1]
  v_pk_fma_f32 v[24:25], v[32:33], v[12:13], v[24:25] op_sel_hi:[1,0,1]
  v_pk_fma_f32 v[26:27], v[34:35], v[12:13], v[26:27] op_sel_hi:[1,0,1]
  v_mov_b32_dpp v12, v61 row_newbcast:9 row_mask:0xf bank_mask:0xf
  s_waitcnt vmcnt(47)
  v_lshlrev_b32 v28, 16, v228
  v_and_b32 v29, s31, v228
  v_lshlrev_b32 v30, 16, v229
  v_and_b32 v31, s31, v229
  v_lshlrev_b32 v32, 16, v230
  v_and_b32 v33, s31, v230
  v_lshlrev_b32 v34, 16, v231
  v_and_b32 v35, s31, v231
  buffer_load_dwordx4 v[228:231], v2, s[8:11], s60 offen offset:1024 nt
  v_pk_fma_f32 v[20:21], v[28:29], v[12:13], v[20:21] op_sel_hi:[1,0,1]
  v_pk_fma_f32 v[22:23], v[30:31], v[12:13], v[22:23] op_sel_hi:[1,0,1]
  v_pk_fma_f32 v[24:25], v[32:33], v[12:13], v[24:25] op_sel_hi:[1,0,1]
  v_pk_fma_f32 v[26:27], v[34:35], v[12:13], v[26:27] op_sel_hi:[1,0,1]
  v_mov_b32_dpp v12, v61 row_newbcast:10 row_mask:0xf bank_mask:0xf
  s_waitcnt vmcnt(47)
  v_lshlrev_b32 v28, 16, v232
  v_and_b32 v29, s31, v232
  v_lshlrev_b32 v30, 16, v233
  v_and_b32 v31, s31, v233
  v_lshlrev_b32 v32, 16, v234
  v_and_b32 v33, s31, v234
  v_lshlrev_b32 v34, 16, v235
  v_and_b32 v35, s31, v235
  buffer_load_dwordx4 v[232:235], v2, s[8:11], s60 offen offset:2048 nt
  v_pk_fma_f32 v[20:21], v[28:29], v[12:13], v[20:21] op_sel_hi:[1,0,1]
  v_pk_fma_f32 v[22:23], v[30:31], v[12:13], v[22:23] op_sel_hi:[1,0,1]
  v_pk_fma_f32 v[24:25], v[32:33], v[12:13], v[24:25] op_sel_hi:[1,0,1]
  v_pk_fma_f32 v[26:27], v[34:35], v[12:13], v[26:27] op_sel_hi:[1,0,1]
  v_mov_b32_dpp v12, v61 row_newbcast:11 row_mask:0xf bank_mask:0xf
  s_waitcnt vmcnt(47)
  v_lshlrev_b32 v28, 16, v236
  v_and_b32 v29, s31, v236
  v_lshlrev_b32 v30, 16, v237
  v_and_b32 v31, s31, v237
  v_lshlrev_b32 v32, 16, v238
  v_and_b32 v33, s31, v238
  v_lshlrev_b32 v34, 16, v239
  v_and_b32 v35, s31, v239
  buffer_load_dwordx4 v[236:239], v2, s[8:11], s60 offen offset:3072 nt
  s_add_u32 s60, s60, s73
  v_pk_fma_f32 v[20:21], v[28:29], v[12:13], v[20:21] op_sel_hi:[1,0,1]
  v_pk_fma_f32 v[22:23], v[30:31], v[12:13], v[22:23] op_sel_hi:[1,0,1]
  v_pk_fma_f32 v[24:25], v[32:33], v[12:13], v[24:25] op_sel_hi:[1,0,1]
  v_pk_fma_f32 v[26:27], v[34:35], v[12:13], v[26:27] op_sel_hi:[1,0,1]
  v_mov_b32_dpp v12, v61 row_newbcast:12 row_mask:0xf bank_mask:0xf
  s_waitcnt vmcnt(47)
  v_lshlrev_b32 v28, 16, v240
  v_and_b32 v29, s31, v240
  v_lshlrev_b32 v30, 16, v241
  v_and_b32 v31, s31, v241
  v_lshlrev_b32 v32, 16, v242
  v_and_b32 v33, s31, v242
  v_lshlrev_b32 v34, 16, v243
  v_and_b32 v35, s31, v243
  buffer_load_dwordx4 v[240:243], v2, s[8:11], s60 offen offset:0 nt
  v_pk_fma_f32 v[20:21], v[28:29], v[12:13], v[20:21] op_sel_hi:[1,0,1]
  v_pk_fma_f32 v[22:23], v[30:31], v[12:13], v[22:23] op_sel_hi:[1,0,1]
  v_pk_fma_f32 v[24:25], v[32:33], v[12:13], v[24:25] op_sel_hi:[1,0,1]
  v_pk_fma_f32 v[26:27], v[34:35], v[12:13], v[26:27] op_sel_hi:[1,0,1]
  v_mov_b32_dpp v12, v61 row_newbcast:13 row_mask:0xf bank_mask:0xf
  s_waitcnt vmcnt(47)
  v_lshlrev_b32 v28, 16, v244
  v_and_b32 v29, s31, v244
  v_lshlrev_b32 v30, 16, v245
  v_and_b32 v31, s31, v245
  v_lshlrev_b32 v32, 16, v246
  v_and_b32 v33, s31, v246
  v_lshlrev_b32 v34, 16, v247
  v_and_b32 v35, s31, v247
  buffer_load_dwordx4 v[244:247], v2, s[8:11], s60 offen offset:1024 nt
  v_pk_fma_f32 v[20:21], v[28:29], v[12:13], v[20:21] op_sel_hi:[1,0,1]
  v_pk_fma_f32 v[22:23], v[30:31], v[12:13], v[22:23] op_sel_hi:[1,0,1]
  v_pk_fma_f32 v[24:25], v[32:33], v[12:13], v[24:25] op_sel_hi:[1,0,1]
  v_pk_fma_f32 v[26:27], v[34:35], v[12:13], v[26:27] op_sel_hi:[1,0,1]
  v_mov_b32_dpp v12, v61 row_newbcast:14 row_mask:0xf bank_mask:0xf
  s_waitcnt vmcnt(47)
  v_lshlrev_b32 v28, 16, v248
  v_and_b32 v29, s31, v248
  v_lshlrev_b32 v30, 16, v249
  v_and_b32 v31, s31, v249
  v_lshlrev_b32 v32, 16, v250
  v_and_b32 v33, s31, v250
  v_lshlrev_b32 v34, 16, v251
  v_and_b32 v35, s31, v251
  buffer_load_dwordx4 v[248:251], v2, s[8:11], s60 offen offset:2048 nt
  v_pk_fma_f32 v[20:21], v[28:29], v[12:13], v[20:21] op_sel_hi:[1,0,1]
  v_pk_fma_f32 v[22:23], v[30:31], v[12:13], v[22:23] op_sel_hi:[1,0,1]
  v_pk_fma_f32 v[24:25], v[32:33], v[12:13], v[24:25] op_sel_hi:[1,0,1]
  v_pk_fma_f32 v[26:27], v[34:35], v[12:13], v[26:27] op_sel_hi:[1,0,1]
  v_mov_b32_dpp v12, v61 row_newbcast:15 row_mask:0xf bank_mask:0xf
  s_waitcnt vmcnt(47)
  v_lshlrev_b32 v28, 16, v252
  v_and_b32 v29, s31, v252
  v_lshlrev_b32 v30, 16, v253
  v_and_b32 v31, s31, v253
  v_lshlrev_b32 v32, 16, v254
  v_and_b32 v33, s31, v254
  v_lshlrev_b32 v34, 16, v255
  v_and_b32 v35, s31, v255
  buffer_load_dwordx4 v[252:255], v2, s[8:11], s60 offen offset:3072 nt
  s_add_u32 s60, s60, s73
  v_pk_fma_f32 v[20:21], v[28:29], v[12:13], v[20:21] op_sel_hi:[1,0,1]
  v_pk_fma_f32 v[22:23], v[30:31], v[12:13], v[22:23] op_sel_hi:[1,0,1]
  v_pk_fma_f32 v[24:25], v[32:33], v[12:13], v[24:25] op_sel_hi:[1,0,1]
  v_pk_fma_f32 v[26:27], v[34:35], v[12:13], v[26:27] op_sel_hi:[1,0,1]
  s_cmp_eq_u32 s61, 35
  s_cbranch_scc0 L1_v0
L1_send:
  s_nop 4
  v_permlane32_swap_b32 v20, v24
  v_permlane32_swap_b32 v21, v25
  v_permlane32_swap_b32 v22, v26
  v_permlane32_swap_b32 v23, v27
  v_add_f32 v20, v20, v24
  v_add_f32 v21, v21, v25
  v_add_f32 v22, v22, v26
  v_add_f32 v23, v23, v27
  s_nop 0
  v_permlane16_swap_b32 v20, v22
  v_permlane16_swap_b32 v21, v23
  v_add_f32 v20, v20, v22
  v_add_f32 v21, v21, v23
  v_add_f32_dpp v10, v10, v10 row_ror:8 row_mask:0xf bank_mask:0xf
  s_nop 1
  v_add_f32_dpp v10, v10, v10 row_ror:4 row_mask:0xf bank_mask:0xf
  s_nop 1
  v_add_f32_dpp v10, v10, v10 row_ror:2 row_mask:0xf bank_mask:0xf
  s_nop 1
  v_add_f32_dpp v10, v10, v10 row_ror:1 row_mask:0xf bank_mask:0xf
  v_mov_b32 v61, v10
  s_nop 1
  v_permlane16_swap_b32 v10, v61
  v_add_f32 v10, v10, v61
  v_mov_b32 v61, v10
  s_nop 1
  v_permlane32_swap_b32 v10, v61
  v_add_f32 v10, v10, v61
  s_lshl_b32 s27, s23, 9
  s_add_u32 s27, s27, 1024
  v_lshlrev_b32 v61, 1, v5
  v_add_u32 v62, s27, v61
  ds_write_b64 v62, v[20:21]
  s_lshl_b32 s27, s23, 2
  s_add_u32 s27, s27, 3072
  v_mov_b32 v62, s27
  ds_write_b32 v62, v9
  ds_write_b32 v62, v10 offset:16
  s_waitcnt lgkmcnt(0)
  s_barrier
  s_endpgm
L1_aux:
  s_nop 4
  s_setprio 2
  s_sub_u32 s72, s23, 4
  v_and_b32 v60, 15, v1
  v_lshlrev_b32 v60, 4, v60
  v_lshrrev_b32 v61, 4, v1
  v_lshl_add_u32 v2, v61, 13, v60
  v_lshl_add_u32 v3, v61, 10, v60
  v_lshlrev_b32 v62, 4, v1
  s_mov_b32 s64, s36
  s_mov_b32 s65, s37
  s_mov_b32 s66, 4096
  s_mov_b32 s67, 0x00020000
  s_mov_b32 s60, s42
  s_mov_b32 s61, s43
  s_mov_b32 s62, 4194304
  s_mov_b32 s63, 0x00020000
  s_lshl_b32 s27, s72, 10
  buffer_load_dwordx4 v[36:39], v62, s[64:67], s27 offen
  s_barrier
  s_lshl_b32 s27, s72, 20
  s_lshl_b32 s28, s25, 8
  s_add_u32 s27, s27, s28
  buffer_load_dwordx4 v[64:67], v2, s[60:63], s27 offen
  s_add_u32 s27, s27, 32768
  buffer_load_dwordx4 v[68:71], v2, s[60:63], s27 offen
  s_add_u32 s27, s27, 32768
  buffer_load_dwordx4 v[72:75], v2, s[60:63], s27 offen
  s_add_u32 s27, s27, 32768
  buffer_load_dwordx4 v[76:79], v2, s[60:63], s27 offen
  s_add_u32 s27, s27, 32768
  buffer_load_dwordx4 v[80:83], v2, s[60:63], s27 offen
  s_add_u32 s27, s27, 32768
  buffer_load_dwordx4 v[84:87], v2, s[60:63], s27 offen
  s_add_u32 s27, s27, 32768
  buffer_load_dwordx4 v[88:91], v2, s[60:63], s27 offen
  s_add_u32 s27, s27, 32768
  buffer_load_dwordx4 v[92:95], v2, s[60:63], s27 offen
  s_add_u32 s27, s27, 32768
  buffer_load_dwordx4 v[96:99], v2, s[60:63], s27 offen
  s_add_u32 s27, s27, 32768
  buffer_load_dwordx4 v[100:103], v2, s[60:63], s27 offen
  s_add_u32 s27, s27, 32768
  buffer_load_dwordx4 v[104:107], v2, s[60:63], s27 offen
  s_add_u32 s27, s27, 32768
  buffer_load_dwordx4 v[108:111], v2, s[60:63], s27 offen
  s_add_u32 s27, s27, 32768
  buffer_load_dwordx4 v[112:115], v2, s[60:63], s27 offen
  s_add_u32 s27, s27, 32768
  buffer_load_dwordx4 v[116:119], v2, s[60:63], s27 offen
  s_add_u32 s27, s27, 32768
  buffer_load_dwordx4 v[120:123], v2, s[60:63], s27 offen
  s_add_u32 s27, s27, 32768
  buffer_load_dwordx4 v[124:127], v2, s[60:63], s27 offen
  s_add_u32 s27, s27, 32768
  buffer_load_dwordx4 v[128:131], v2, s[60:63], s27 offen
  s_add_u32 s27, s27, 32768
  buffer_load_dwordx4 v[132:135], v2, s[60:63], s27 offen
  s_add_u32 s27, s27, 32768
  buffer_load_dwordx4 v[136:139], v2, s[60:63], s27 offen
  s_add_u32 s27, s27, 32768
  buffer_load_dwordx4 v[140:143], v2, s[60:63], s27 offen
  s_add_u32 s27, s27, 32768
  buffer_load_dwordx4 v[144:147], v2, s[60:63], s27 offen
  s_add_u32 s27, s27, 32768
  buffer_load_dwordx4 v[148:151], v2, s[60:63], s27 offen
  s_add_u32 s27, s27, 32768
  buffer_load_dwordx4 v[152:155], v2, s[60:63], s27 offen
  s_add_u32 s27, s27, 32768
  buffer_load_dwordx4 v[156:159], v2, s[60:63], s27 offen
  s_add_u32 s27, s27, 32768
  buffer_load_dwordx4 v[160:163], v2, s[60:63], s27 offen
  s_add_u32 s27, s27, 32768
  buffer_load_dwordx4 v[164:167], v2, s[60:63], s27 offen
  s_add_u32 s27, s27, 32768
  buffer_load_dwordx4 v[168:171], v2, s[60:63], s27 offen
  s_add_u32 s27, s27, 32768
  buffer_load_dwordx4 v[172:175], v2, s[60:63], s27 offen
  s_add_u32 s27, s27, 32768
  buffer_load_dwordx4 v[176:179], v2, s[60:63], s27 offen
  s_add_u32 s27, s27, 32768
  buffer_load_dwordx4 v[180:183], v2, s[60:63], s27 offen
  s_add_u32 s27, s27, 32768
  buffer_load_dwordx4 v[184:187], v2, s[60:63], s27 offen
  s_add_u32 s27, s27, 32768
  buffer_load_dwordx4 v[188:191], v2, s[60:63], s27 offen
  v_lshrrev_b32 v60, 2, v1
  v_mul_u32_u24 v60, 3584, v60
  v_and_b32 v61, 3, v1
  v_lshl_add_u32 v4, v61, 4, v60
  s_waitcnt vmcnt(32)
  v_lshlrev_b32 v28, 16, v36
  v_and_b32 v29, s31, v36
  v_lshlrev_b32 v30, 16, v37
  v_and_b32 v31, s31, v37
  v_lshlrev_b32 v32, 16, v38
  v_and_b32 v33, s31, v38
  v_lshlrev_b32 v34, 16, v39
  v_and_b32 v35, s31, v39
  v_add_f32 v60, v28, v29
  v_add_f32 v60, v60, v30
  v_add_f32 v60, v60, v31
  v_add_f32 v60, v60, v32
  v_add_f32 v60, v60, v33
  v_add_f32 v60, v60, v34
  v_add_f32 v60, v60, v35
  s_nop 1
  v_add_f32_dpp v60, v60, v60 row_ror:8 row_mask:0xf bank_mask:0xf
  s_nop 1
  v_add_f32_dpp v60, v60, v60 row_ror:4 row_mask:0xf bank_mask:0xf
  s_nop 1
  v_add_f32_dpp v60, v60, v60 row_ror:2 row_mask:0xf bank_mask:0xf
  s_nop 1
  v_add_f32_dpp v60, v60, v60 row_ror:1 row_mask:0xf bank_mask:0xf
  v_mov_b32 v62, v60
  s_nop 1
  v_permlane16_swap_b32 v60, v62
  v_add_f32 v60, v60, v62
  v_mov_b32 v62, v60
  s_nop 1
  v_permlane32_swap_b32 v60, v62
  v_add_f32 v60, v60, v62
  v_mul_f32 v60, 0x3b000000, v60
  v_mov_b32 v61, 0
  v_sub_f32 v62, v28, v60
  v_fmac_f32 v61, v62, v62
  v_sub_f32 v62, v29, v60
  v_fmac_f32 v61, v62, v62
  v_sub_f32 v62, v30, v60
  v_fmac_f32 v61, v62, v62
  v_sub_f32 v62, v31, v60
  v_fmac_f32 v61, v62, v62
  v_sub_f32 v62, v32, v60
  v_fmac_f32 v61, v62, v62
  v_sub_f32 v62, v33, v60
  v_fmac_f32 v61, v62, v62
  v_sub_f32 v62, v34, v60
  v_fmac_f32 v61, v62, v62
  v_sub_f32 v62, v35, v60
  v_fmac_f32 v61, v62, v62
  s_nop 1
  v_add_f32_dpp v61, v61, v61 row_ror:8 row_mask:0xf bank_mask:0xf
  s_nop 1
  v_add_f32_dpp v61, v61, v61 row_ror:4 row_mask:0xf bank_mask:0xf
  s_nop 1
  v_add_f32_dpp v61, v61, v61 row_ror:2 row_mask:0xf bank_mask:0xf
  s_nop 1
  v_add_f32_dpp v61, v61, v61 row_ror:1 row_mask:0xf bank_mask:0xf
  v_mov_b32 v62, v61
  s_nop 1
  v_permlane16_swap_b32 v61, v62
  v_add_f32 v61, v61, v62
  v_mov_b32 v62, v61
  s_nop 1
  v_permlane32_swap_b32 v61, v62
  v_add_f32 v61, v61, v62
  v_mul_f32 v61, 0x3b000000, v61
  v_cvt_pk_bf16_f32 v60, v60, v60
  v_lshlrev_b32 v60, 16, v60
  v_cvt_pk_bf16_f32 v61, v61, v61
  v_lshlrev_b32 v61, 16, v61
  v_add_f32 v61, 925353388, v61
  v_cvt_pk_bf16_f32 v61, v61, v61
  v_lshlrev_b32 v61, 16, v61
  v_sqrt_f32 v61, v61
  s_nop 0
  v_cvt_pk_bf16_f32 v61, v61, v61
  v_lshlrev_b32 v61, 16, v61
  v_rcp_f32 v62, v61
  v_sub_f32 v28, v28, v60
  v_cvt_pk_bf16_f32 v28, v28, v28
  v_lshlrev_b32 v28, 16, v28
  v_mul_f32 v63, v28, v62
  v_fma_f32 v28, -v63, v61, v28
  v_fma_f32 v28, v28, v62, v63
  v_cvt_pk_bf16_f32 v28, v28, v28
  v_lshlrev_b32 v28, 16, v28
  v_sub_f32 v29, v29, v60
  v_cvt_pk_bf16_f32 v29, v29, v29
  v_lshlrev_b32 v29, 16, v29
  v_mul_f32 v63, v29, v62
  v_fma_f32 v29, -v63, v61, v29
  v_fma_f32 v29, v29, v62, v63
  v_cvt_pk_bf16_f32 v29, v29, v29
  v_lshlrev_b32 v29, 16, v29
  v_sub_f32 v30, v30, v60
  v_cvt_pk_bf16_f32 v30, v30, v30
  v_lshlrev_b32 v30, 16, v30
  v_mul_f32 v63, v30, v62
  v_fma_f32 v30, -v63, v61, v30
  v_fma_f32 v30, v30, v62, v63
  v_cvt_pk_bf16_f32 v30, v30, v30
  v_lshlrev_b32 v30, 16, v30
  v_sub_f32 v31, v31, v60
  v_cvt_pk_bf16_f32 v31, v31, v31
  v_lshlrev_b32 v31, 16, v31
  v_mul_f32 v63, v31, v62
  v_fma_f32 v31, -v63, v61, v31
  v_fma_f32 v31, v31, v62, v63
  v_cvt_pk_bf16_f32 v31, v31, v31
  v_lshlrev_b32 v31, 16, v31
  v_sub_f32 v32, v32, v60
  v_cvt_pk_bf16_f32 v32, v32, v32
  v_lshlrev_b32 v32, 16, v32
  v_mul_f32 v63, v32, v62
  v_fma_f32 v32, -v63, v61, v32
  v_fma_f32 v32, v32, v62, v63
  v_cvt_pk_bf16_f32 v32, v32, v32
  v_lshlrev_b32 v32, 16, v32
  v_sub_f32 v33, v33, v60
  v_cvt_pk_bf16_f32 v33, v33, v33
  v_lshlrev_b32 v33, 16, v33
  v_mul_f32 v63, v33, v62
  v_fma_f32 v33, -v63, v61, v33
  v_fma_f32 v33, v33, v62, v63
  v_cvt_pk_bf16_f32 v33, v33, v33
  v_lshlrev_b32 v33, 16, v33
  v_sub_f32 v34, v34, v60
  v_cvt_pk_bf16_f32 v34, v34, v34
  v_lshlrev_b32 v34, 16, v34
  v_mul_f32 v63, v34, v62
  v_fma_f32 v34, -v63, v61, v34
  v_fma_f32 v34, v34, v62, v63
  v_cvt_pk_bf16_f32 v34, v34, v34
  v_lshlrev_b32 v34, 16, v34
  v_sub_f32 v35, v35, v60
  v_cvt_pk_bf16_f32 v35, v35, v35
  v_lshlrev_b32 v35, 16, v35
  v_mul_f32 v63, v35, v62
  v_fma_f32 v35, -v63, v61, v35
  v_fma_f32 v35, v35, v62, v63
  v_cvt_pk_bf16_f32 v35, v35, v35
  v_lshlrev_b32 v35, 16, v35
  s_lshl_b32 s27, s72, 11
  s_add_u32 s27, s27, 4096
  v_lshl_add_u32 v60, v1, 5, s27
  ds_write_b128 v60, v[28:31]
  ds_write_b128 v60, v[32:35] offset:16
  s_lshl_b32 s27, s72, 2
  v_mov_b32 v61, s27
  v_mov_b32 v62, 1
  ds_write_b32 v61, v62 offset:32
  v_mov_b32 v61, 32
L1_xpoll:
  s_nop 4
  ds_read_b128 v[28:31], v61
  s_waitcnt lgkmcnt(0)
  v_and_b32 v28, v28, v29
  v_and_b32 v30, v30, v31
  v_and_b32 v28, v28, v30
  s_nop 0
  v_readfirstlane_b32 s27, v28
  s_nop 0
  s_cmp_eq_u32 s27, 1
  s_cbranch_scc1 L1_xpoll_ok
  s_sleep 1
  s_branch L1_xpoll
L1_xpoll_ok:
  s_nop 4
  s_lshl_b32 s27, s24, 11
  s_lshl_b32 s28, s72, 9
  s_add_u32 s27, s27, s28
  v_add_u32 v61, s27, v5
  ds_read_b32 v18, v61 offset:4096
  ds_read_b32 v19, v61 offset:4352
  v_mov_b32 v20, 0
  v_mov_b32 v21, 0
  v_mov_b32 v22, 0
  v_mov_b32 v23, 0
  v_mov_b32 v24, 0
  v_mov_b32 v25, 0
  v_mov_b32 v26, 0
  v_mov_b32 v27, 0
  s_waitcnt lgkmcnt(0)
  v_mov_b32_dpp v12, v18 row_newbcast:0 row_mask:0xf bank_mask:0xf
  s_waitcnt vmcnt(31)
  v_lshlrev_b32 v28, 16, v64
  v_and_b32 v29, s31, v64
  v_lshlrev_b32 v30, 16, v65
  v_and_b32 v31, s31, v65
  v_lshlrev_b32 v32, 16, v66
  v_and_b32 v33, s31, v66
  v_lshlrev_b32 v34, 16, v67
  v_and_b32 v35, s31, v67
  v_pk_fma_f32 v[20:21], v[28:29], v[12:13], v[20:21] op_sel_hi:[1,0,1]
  v_pk_fma_f32 v[22:23], v[30:31], v[12:13], v[22:23] op_sel_hi:[1,0,1]
  v_pk_fma_f32 v[24:25], v[32:33], v[12:13], v[24:25] op_sel_hi:[1,0,1]
  v_pk_fma_f32 v[26:27], v[34:35], v[12:13], v[26:27] op_sel_hi:[1,0,1]
  v_mov_b32_dpp v12, v18 row_newbcast:1 row_mask:0xf bank_mask:0xf
  s_waitcnt vmcnt(30)
  v_lshlrev_b32 v28, 16, v68
  v_and_b32 v29, s31, v68
  v_lshlrev_b32 v30, 16, v69
  v_and_b32 v31, s31, v69
  v_lshlrev_b32 v32, 16, v70
  v_and_b32 v33, s31, v70
  v_lshlrev_b32 v34, 16, v71
  v_and_b32 v35, s31, v71
  v_pk_fma_f32 v[20:21], v[28:29], v[12:13], v[20:21] op_sel_hi:[1,0,1]
  v_pk_fma_f32 v[22:23], v[30:31], v[12:13], v[22:23] op_sel_hi:[1,0,1]
  v_pk_fma_f32 v[24:25], v[32:33], v[12:13], v[24:25] op_sel_hi:[1,0,1]
  v_pk_fma_f32 v[26:27], v[34:35], v[12:13], v[26:27] op_sel_hi:[1,0,1]
  v_mov_b32_dpp v12, v18 row_newbcast:2 row_mask:0xf bank_mask:0xf
  s_waitcnt vmcnt(29)
  v_lshlrev_b32 v28, 16, v72
  v_and_b32 v29, s31, v72
  v_lshlrev_b32 v30, 16, v73
  v_and_b32 v31, s31, v73
  v_lshlrev_b32 v32, 16, v74
  v_and_b32 v33, s31, v74
  v_lshlrev_b32 v34, 16, v75
  v_and_b32 v35, s31, v75
  v_pk_fma_f32 v[20:21], v[28:29], v[12:13], v[20:21] op_sel_hi:[1,0,1]
  v_pk_fma_f32 v[22:23], v[30:31], v[12:13], v[22:23] op_sel_hi:[1,0,1]
  v_pk_fma_f32 v[24:25], v[32:33], v[12:13], v[24:25] op_sel_hi:[1,0,1]
  v_pk_fma_f32 v[26:27], v[34:35], v[12:13], v[26:27] op_sel_hi:[1,0,1]
  v_mov_b32_dpp v12, v18 row_newbcast:3 row_mask:0xf bank_mask:0xf
  s_waitcnt vmcnt(28)
  v_lshlrev_b32 v28, 16, v76
  v_and_b32 v29, s31, v76
  v_lshlrev_b32 v30, 16, v77
  v_and_b32 v31, s31, v77
  v_lshlrev_b32 v32, 16, v78
  v_and_b32 v33, s31, v78
  v_lshlrev_b32 v34, 16, v79
  v_and_b32 v35, s31, v79
  v_pk_fma_f32 v[20:21], v[28:29], v[12:13], v[20:21] op_sel_hi:[1,0,1]
  v_pk_fma_f32 v[22:23], v[30:31], v[12:13], v[22:23] op_sel_hi:[1,0,1]
  v_pk_fma_f32 v[24:25], v[32:33], v[12:13], v[24:25] op_sel_hi:[1,0,1]
  v_pk_fma_f32 v[26:27], v[34:35], v[12:13], v[26:27] op_sel_hi:[1,0,1]
  v_mov_b32_dpp v12, v18 row_newbcast:4 row_mask:0xf bank_mask:0xf
  s_waitcnt vmcnt(27)
  v_lshlrev_b32 v28, 16, v80
  v_and_b32 v29, s31, v80
  v_lshlrev_b32 v30, 16, v81
  v_and_b32 v31, s31, v81
  v_lshlrev_b32 v32, 16, v82
  v_and_b32 v33, s31, v82
  v_lshlrev_b32 v34, 16, v83
  v_and_b32 v35, s31, v83
  v_pk_fma_f32 v[20:21], v[28:29], v[12:13], v[20:21] op_sel_hi:[1,0,1]
  v_pk_fma_f32 v[22:23], v[30:31], v[12:13], v[22:23] op_sel_hi:[1,0,1]
  v_pk_fma_f32 v[24:25], v[32:33], v[12:13], v[24:25] op_sel_hi:[1,0,1]
  v_pk_fma_f32 v[26:27], v[34:35], v[12:13], v[26:27] op_sel_hi:[1,0,1]
  v_mov_b32_dpp v12, v18 row_newbcast:5 row_mask:0xf bank_mask:0xf
  s_waitcnt vmcnt(26)
  v_lshlrev_b32 v28, 16, v84
  v_and_b32 v29, s31, v84
  v_lshlrev_b32 v30, 16, v85
  v_and_b32 v31, s31, v85
  v_lshlrev_b32 v32, 16, v86
  v_and_b32 v33, s31, v86
  v_lshlrev_b32 v34, 16, v87
  v_and_b32 v35, s31, v87
  v_pk_fma_f32 v[20:21], v[28:29], v[12:13], v[20:21] op_sel_hi:[1,0,1]
  v_pk_fma_f32 v[22:23], v[30:31], v[12:13], v[22:23] op_sel_hi:[1,0,1]
  v_pk_fma_f32 v[24:25], v[32:33], v[12:13], v[24:25] op_sel_hi:[1,0,1]
  v_pk_fma_f32 v[26:27], v[34:35], v[12:13], v[26:27] op_sel_hi:[1,0,1]
  v_mov_b32_dpp v12, v18 row_newbcast:6 row_mask:0xf bank_mask:0xf
  s_waitcnt vmcnt(25)
  v_lshlrev_b32 v28, 16, v88
  v_and_b32 v29, s31, v88
  v_lshlrev_b32 v30, 16, v89
  v_and_b32 v31, s31, v89
  v_lshlrev_b32 v32, 16, v90
  v_and_b32 v33, s31, v90
  v_lshlrev_b32 v34, 16, v91
  v_and_b32 v35, s31, v91
  v_pk_fma_f32 v[20:21], v[28:29], v[12:13], v[20:21] op_sel_hi:[1,0,1]
  v_pk_fma_f32 v[22:23], v[30:31], v[12:13], v[22:23] op_sel_hi:[1,0,1]
  v_pk_fma_f32 v[24:25], v[32:33], v[12:13], v[24:25] op_sel_hi:[1,0,1]
  v_pk_fma_f32 v[26:27], v[34:35], v[12:13], v[26:27] op_sel_hi:[1,0,1]
  v_mov_b32_dpp v12, v18 row_newbcast:7 row_mask:0xf bank_mask:0xf
  s_waitcnt vmcnt(24)
  v_lshlrev_b32 v28, 16, v92
  v_and_b32 v29, s31, v92
  v_lshlrev_b32 v30, 16, v93
  v_and_b32 v31, s31, v93
  v_lshlrev_b32 v32, 16, v94
  v_and_b32 v33, s31, v94
  v_lshlrev_b32 v34, 16, v95
  v_and_b32 v35, s31, v95
  v_pk_fma_f32 v[20:21], v[28:29], v[12:13], v[20:21] op_sel_hi:[1,0,1]
  v_pk_fma_f32 v[22:23], v[30:31], v[12:13], v[22:23] op_sel_hi:[1,0,1]
  v_pk_fma_f32 v[24:25], v[32:33], v[12:13], v[24:25] op_sel_hi:[1,0,1]
  v_pk_fma_f32 v[26:27], v[34:35], v[12:13], v[26:27] op_sel_hi:[1,0,1]
  v_mov_b32_dpp v12, v18 row_newbcast:8 row_mask:0xf bank_mask:0xf
  s_waitcnt vmcnt(23)
  v_lshlrev_b32 v28, 16, v96
  v_and_b32 v29, s31, v96
  v_lshlrev_b32 v30, 16, v97
  v_and_b32 v31, s31, v97
  v_lshlrev_b32 v32, 16, v98
  v_and_b32 v33, s31, v98
  v_lshlrev_b32 v34, 16, v99
  v_and_b32 v35, s31, v99
  v_pk_fma_f32 v[20:21], v[28:29], v[12:13], v[20:21] op_sel_hi:[1,0,1]
  v_pk_fma_f32 v[22:23], v[30:31], v[12:13], v[22:23] op_sel_hi:[1,0,1]
  v_pk_fma_f32 v[24:25], v[32:33], v[12:13], v[24:25] op_sel_hi:[1,0,1]
  v_pk_fma_f32 v[26:27], v[34:35], v[12:13], v[26:27] op_sel_hi:[1,0,1]
  v_mov_b32_dpp v12, v18 row_newbcast:9 row_mask:0xf bank_mask:0xf
  s_waitcnt vmcnt(22)
  v_lshlrev_b32 v28, 16, v100
  v_and_b32 v29, s31, v100
  v_lshlrev_b32 v30, 16, v101
  v_and_b32 v31, s31, v101
  v_lshlrev_b32 v32, 16, v102
  v_and_b32 v33, s31, v102
  v_lshlrev_b32 v34, 16, v103
  v_and_b32 v35, s31, v103
  v_pk_fma_f32 v[20:21], v[28:29], v[12:13], v[20:21] op_sel_hi:[1,0,1]
  v_pk_fma_f32 v[22:23], v[30:31], v[12:13], v[22:23] op_sel_hi:[1,0,1]
  v_pk_fma_f32 v[24:25], v[32:33], v[12:13], v[24:25] op_sel_hi:[1,0,1]
  v_pk_fma_f32 v[26:27], v[34:35], v[12:13], v[26:27] op_sel_hi:[1,0,1]
  v_mov_b32_dpp v12, v18 row_newbcast:10 row_mask:0xf bank_mask:0xf
  s_waitcnt vmcnt(21)
  v_lshlrev_b32 v28, 16, v104
  v_and_b32 v29, s31, v104
  v_lshlrev_b32 v30, 16, v105
  v_and_b32 v31, s31, v105
  v_lshlrev_b32 v32, 16, v106
  v_and_b32 v33, s31, v106
  v_lshlrev_b32 v34, 16, v107
  v_and_b32 v35, s31, v107
  v_pk_fma_f32 v[20:21], v[28:29], v[12:13], v[20:21] op_sel_hi:[1,0,1]
  v_pk_fma_f32 v[22:23], v[30:31], v[12:13], v[22:23] op_sel_hi:[1,0,1]
  v_pk_fma_f32 v[24:25], v[32:33], v[12:13], v[24:25] op_sel_hi:[1,0,1]
  v_pk_fma_f32 v[26:27], v[34:35], v[12:13], v[26:27] op_sel_hi:[1,0,1]
  v_mov_b32_dpp v12, v18 row_newbcast:11 row_mask:0xf bank_mask:0xf
  s_waitcnt vmcnt(20)
  v_lshlrev_b32 v28, 16, v108
  v_and_b32 v29, s31, v108
  v_lshlrev_b32 v30, 16, v109
  v_and_b32 v31, s31, v109
  v_lshlrev_b32 v32, 16, v110
  v_and_b32 v33, s31, v110
  v_lshlrev_b32 v34, 16, v111
  v_and_b32 v35, s31, v111
  v_pk_fma_f32 v[20:21], v[28:29], v[12:13], v[20:21] op_sel_hi:[1,0,1]
  v_pk_fma_f32 v[22:23], v[30:31], v[12:13], v[22:23] op_sel_hi:[1,0,1]
  v_pk_fma_f32 v[24:25], v[32:33], v[12:13], v[24:25] op_sel_hi:[1,0,1]
  v_pk_fma_f32 v[26:27], v[34:35], v[12:13], v[26:27] op_sel_hi:[1,0,1]
  v_mov_b32_dpp v12, v18 row_newbcast:12 row_mask:0xf bank_mask:0xf
  s_waitcnt vmcnt(19)
  v_lshlrev_b32 v28, 16, v112
  v_and_b32 v29, s31, v112
  v_lshlrev_b32 v30, 16, v113
  v_and_b32 v31, s31, v113
  v_lshlrev_b32 v32, 16, v114
  v_and_b32 v33, s31, v114
  v_lshlrev_b32 v34, 16, v115
  v_and_b32 v35, s31, v115
  v_pk_fma_f32 v[20:21], v[28:29], v[12:13], v[20:21] op_sel_hi:[1,0,1]
  v_pk_fma_f32 v[22:23], v[30:31], v[12:13], v[22:23] op_sel_hi:[1,0,1]
  v_pk_fma_f32 v[24:25], v[32:33], v[12:13], v[24:25] op_sel_hi:[1,0,1]
  v_pk_fma_f32 v[26:27], v[34:35], v[12:13], v[26:27] op_sel_hi:[1,0,1]
  v_mov_b32_dpp v12, v18 row_newbcast:13 row_mask:0xf bank_mask:0xf
  s_waitcnt vmcnt(18)
  v_lshlrev_b32 v28, 16, v116
  v_and_b32 v29, s31, v116
  v_lshlrev_b32 v30, 16, v117
  v_and_b32 v31, s31, v117
  v_lshlrev_b32 v32, 16, v118
  v_and_b32 v33, s31, v118
  v_lshlrev_b32 v34, 16, v119
  v_and_b32 v35, s31, v119
  v_pk_fma_f32 v[20:21], v[28:29], v[12:13], v[20:21] op_sel_hi:[1,0,1]
  v_pk_fma_f32 v[22:23], v[30:31], v[12:13], v[22:23] op_sel_hi:[1,0,1]
  v_pk_fma_f32 v[24:25], v[32:33], v[12:13], v[24:25] op_sel_hi:[1,0,1]
  v_pk_fma_f32 v[26:27], v[34:35], v[12:13], v[26:27] op_sel_hi:[1,0,1]
  v_mov_b32_dpp v12, v18 row_newbcast:14 row_mask:0xf bank_mask:0xf
  s_waitcnt vmcnt(17)
  v_lshlrev_b32 v28, 16, v120
  v_and_b32 v29, s31, v120
  v_lshlrev_b32 v30, 16, v121
  v_and_b32 v31, s31, v121
  v_lshlrev_b32 v32, 16, v122
  v_and_b32 v33, s31, v122
  v_lshlrev_b32 v34, 16, v123
  v_and_b32 v35, s31, v123
  v_pk_fma_f32 v[20:21], v[28:29], v[12:13], v[20:21] op_sel_hi:[1,0,1]
  v_pk_fma_f32 v[22:23], v[30:31], v[12:13], v[22:23] op_sel_hi:[1,0,1]
  v_pk_fma_f32 v[24:25], v[32:33], v[12:13], v[24:25] op_sel_hi:[1,0,1]
  v_pk_fma_f32 v[26:27], v[34:35], v[12:13], v[26:27] op_sel_hi:[1,0,1]
  v_mov_b32_dpp v12, v18 row_newbcast:15 row_mask:0xf bank_mask:0xf
  s_waitcnt vmcnt(16)
  v_lshlrev_b32 v28, 16, v124
  v_and_b32 v29, s31, v124
  v_lshlrev_b32 v30, 16, v125
  v_and_b32 v31, s31, v125
  v_lshlrev_b32 v32, 16, v126
  v_and_b32 v33, s31, v126
  v_lshlrev_b32 v34, 16, v127
  v_and_b32 v35, s31, v127
  v_pk_fma_f32 v[20:21], v[28:29], v[12:13], v[20:21] op_sel_hi:[1,0,1]
  v_pk_fma_f32 v[22:23], v[30:31], v[12:13], v[22:23] op_sel_hi:[1,0,1]
  v_pk_fma_f32 v[24:25], v[32:33], v[12:13], v[24:25] op_sel_hi:[1,0,1]
  v_pk_fma_f32 v[26:27], v[34:35], v[12:13], v[26:27] op_sel_hi:[1,0,1]
  v_mov_b32_dpp v12, v19 row_newbcast:0 row_mask:0xf bank_mask:0xf
  s_waitcnt vmcnt(15)
  v_lshlrev_b32 v28, 16, v128
  v_and_b32 v29, s31, v128
  v_lshlrev_b32 v30, 16, v129
  v_and_b32 v31, s31, v129
  v_lshlrev_b32 v32, 16, v130
  v_and_b32 v33, s31, v130
  v_lshlrev_b32 v34, 16, v131
  v_and_b32 v35, s31, v131
  v_pk_fma_f32 v[20:21], v[28:29], v[12:13], v[20:21] op_sel_hi:[1,0,1]
  v_pk_fma_f32 v[22:23], v[30:31], v[12:13], v[22:23] op_sel_hi:[1,0,1]
  v_pk_fma_f32 v[24:25], v[32:33], v[12:13], v[24:25] op_sel_hi:[1,0,1]
  v_pk_fma_f32 v[26:27], v[34:35], v[12:13], v[26:27] op_sel_hi:[1,0,1]
  v_mov_b32_dpp v12, v19 row_newbcast:1 row_mask:0xf bank_mask:0xf
  s_waitcnt vmcnt(14)
  v_lshlrev_b32 v28, 16, v132
  v_and_b32 v29, s31, v132
  v_lshlrev_b32 v30, 16, v133
  v_and_b32 v31, s31, v133
  v_lshlrev_b32 v32, 16, v134
  v_and_b32 v33, s31, v134
  v_lshlrev_b32 v34, 16, v135
  v_and_b32 v35, s31, v135
  v_pk_fma_f32 v[20:21], v[28:29], v[12:13], v[20:21] op_sel_hi:[1,0,1]
  v_pk_fma_f32 v[22:23], v[30:31], v[12:13], v[22:23] op_sel_hi:[1,0,1]
  v_pk_fma_f32 v[24:25], v[32:33], v[12:13], v[24:25] op_sel_hi:[1,0,1]
  v_pk_fma_f32 v[26:27], v[34:35], v[12:13], v[26:27] op_sel_hi:[1,0,1]
  v_mov_b32_dpp v12, v19 row_newbcast:2 row_mask:0xf bank_mask:0xf
  s_waitcnt vmcnt(13)
  v_lshlrev_b32 v28, 16, v136
  v_and_b32 v29, s31, v136
  v_lshlrev_b32 v30, 16, v137
  v_and_b32 v31, s31, v137
  v_lshlrev_b32 v32, 16, v138
  v_and_b32 v33, s31, v138
  v_lshlrev_b32 v34, 16, v139
  v_and_b32 v35, s31, v139
  v_pk_fma_f32 v[20:21], v[28:29], v[12:13], v[20:21] op_sel_hi:[1,0,1]
  v_pk_fma_f32 v[22:23], v[30:31], v[12:13], v[22:23] op_sel_hi:[1,0,1]
  v_pk_fma_f32 v[24:25], v[32:33], v[12:13], v[24:25] op_sel_hi:[1,0,1]
  v_pk_fma_f32 v[26:27], v[34:35], v[12:13], v[26:27] op_sel_hi:[1,0,1]
  v_mov_b32_dpp v12, v19 row_newbcast:3 row_mask:0xf bank_mask:0xf
  s_waitcnt vmcnt(12)
  v_lshlrev_b32 v28, 16, v140
  v_and_b32 v29, s31, v140
  v_lshlrev_b32 v30, 16, v141
  v_and_b32 v31, s31, v141
  v_lshlrev_b32 v32, 16, v142
  v_and_b32 v33, s31, v142
  v_lshlrev_b32 v34, 16, v143
  v_and_b32 v35, s31, v143
  v_pk_fma_f32 v[20:21], v[28:29], v[12:13], v[20:21] op_sel_hi:[1,0,1]
  v_pk_fma_f32 v[22:23], v[30:31], v[12:13], v[22:23] op_sel_hi:[1,0,1]
  v_pk_fma_f32 v[24:25], v[32:33], v[12:13], v[24:25] op_sel_hi:[1,0,1]
  v_pk_fma_f32 v[26:27], v[34:35], v[12:13], v[26:27] op_sel_hi:[1,0,1]
  v_mov_b32_dpp v12, v19 row_newbcast:4 row_mask:0xf bank_mask:0xf
  s_waitcnt vmcnt(11)
  v_lshlrev_b32 v28, 16, v144
  v_and_b32 v29, s31, v144
  v_lshlrev_b32 v30, 16, v145
  v_and_b32 v31, s31, v145
  v_lshlrev_b32 v32, 16, v146
  v_and_b32 v33, s31, v146
  v_lshlrev_b32 v34, 16, v147
  v_and_b32 v35, s31, v147
  v_pk_fma_f32 v[20:21], v[28:29], v[12:13], v[20:21] op_sel_hi:[1,0,1]
  v_pk_fma_f32 v[22:23], v[30:31], v[12:13], v[22:23] op_sel_hi:[1,0,1]
  v_pk_fma_f32 v[24:25], v[32:33], v[12:13], v[24:25] op_sel_hi:[1,0,1]
  v_pk_fma_f32 v[26:27], v[34:35], v[12:13], v[26:27] op_sel_hi:[1,0,1]
  v_mov_b32_dpp v12, v19 row_newbcast:5 row_mask:0xf bank_mask:0xf
  s_waitcnt vmcnt(10)
  v_lshlrev_b32 v28, 16, v148
  v_and_b32 v29, s31, v148
  v_lshlrev_b32 v30, 16, v149
  v_and_b32 v31, s31, v149
  v_lshlrev_b32 v32, 16, v150
  v_and_b32 v33, s31, v150
  v_lshlrev_b32 v34, 16, v151
  v_and_b32 v35, s31, v151
  v_pk_fma_f32 v[20:21], v[28:29], v[12:13], v[20:21] op_sel_hi:[1,0,1]
  v_pk_fma_f32 v[22:23], v[30:31], v[12:13], v[22:23] op_sel_hi:[1,0,1]
  v_pk_fma_f32 v[24:25], v[32:33], v[12:13], v[24:25] op_sel_hi:[1,0,1]
  v_pk_fma_f32 v[26:27], v[34:35], v[12:13], v[26:27] op_sel_hi:[1,0,1]
  v_mov_b32_dpp v12, v19 row_newbcast:6 row_mask:0xf bank_mask:0xf
  s_waitcnt vmcnt(9)
  v_lshlrev_b32 v28, 16, v152
  v_and_b32 v29, s31, v152
  v_lshlrev_b32 v30, 16, v153
  v_and_b32 v31, s31, v153
  v_lshlrev_b32 v32, 16, v154
  v_and_b32 v33, s31, v154
  v_lshlrev_b32 v34, 16, v155
  v_and_b32 v35, s31, v155
  v_pk_fma_f32 v[20:21], v[28:29], v[12:13], v[20:21] op_sel_hi:[1,0,1]
  v_pk_fma_f32 v[22:23], v[30:31], v[12:13], v[22:23] op_sel_hi:[1,0,1]
  v_pk_fma_f32 v[24:25], v[32:33], v[12:13], v[24:25] op_sel_hi:[1,0,1]
  v_pk_fma_f32 v[26:27], v[34:35], v[12:13], v[26:27] op_sel_hi:[1,0,1]
  v_mov_b32_dpp v12, v19 row_newbcast:7 row_mask:0xf bank_mask:0xf
  s_waitcnt vmcnt(8)
  v_lshlrev_b32 v28, 16, v156
  v_and_b32 v29, s31, v156
  v_lshlrev_b32 v30, 16, v157
  v_and_b32 v31, s31, v157
  v_lshlrev_b32 v32, 16, v158
  v_and_b32 v33, s31, v158
  v_lshlrev_b32 v34, 16, v159
  v_and_b32 v35, s31, v159
  v_pk_fma_f32 v[20:21], v[28:29], v[12:13], v[20:21] op_sel_hi:[1,0,1]
  v_pk_fma_f32 v[22:23], v[30:31], v[12:13], v[22:23] op_sel_hi:[1,0,1]
  v_pk_fma_f32 v[24:25], v[32:33], v[12:13], v[24:25] op_sel_hi:[1,0,1]
  v_pk_fma_f32 v[26:27], v[34:35], v[12:13], v[26:27] op_sel_hi:[1,0,1]
  v_mov_b32_dpp v12, v19 row_newbcast:8 row_mask:0xf bank_mask:0xf
  s_waitcnt vmcnt(7)
  v_lshlrev_b32 v28, 16, v160
  v_and_b32 v29, s31, v160
  v_lshlrev_b32 v30, 16, v161
  v_and_b32 v31, s31, v161
  v_lshlrev_b32 v32, 16, v162
  v_and_b32 v33, s31, v162
  v_lshlrev_b32 v34, 16, v163
  v_and_b32 v35, s31, v163
  v_pk_fma_f32 v[20:21], v[28:29], v[12:13], v[20:21] op_sel_hi:[1,0,1]
  v_pk_fma_f32 v[22:23], v[30:31], v[12:13], v[22:23] op_sel_hi:[1,0,1]
  v_pk_fma_f32 v[24:25], v[32:33], v[12:13], v[24:25] op_sel_hi:[1,0,1]
  v_pk_fma_f32 v[26:27], v[34:35], v[12:13], v[26:27] op_sel_hi:[1,0,1]
  v_mov_b32_dpp v12, v19 row_newbcast:9 row_mask:0xf bank_mask:0xf
  s_waitcnt vmcnt(6)
  v_lshlrev_b32 v28, 16, v164
  v_and_b32 v29, s31, v164
  v_lshlrev_b32 v30, 16, v165
  v_and_b32 v31, s31, v165
  v_lshlrev_b32 v32, 16, v166
  v_and_b32 v33, s31, v166
  v_lshlrev_b32 v34, 16, v167
  v_and_b32 v35, s31, v167
  v_pk_fma_f32 v[20:21], v[28:29], v[12:13], v[20:21] op_sel_hi:[1,0,1]
  v_pk_fma_f32 v[22:23], v[30:31], v[12:13], v[22:23] op_sel_hi:[1,0,1]
  v_pk_fma_f32 v[24:25], v[32:33], v[12:13], v[24:25] op_sel_hi:[1,0,1]
  v_pk_fma_f32 v[26:27], v[34:35], v[12:13], v[26:27] op_sel_hi:[1,0,1]
  v_mov_b32_dpp v12, v19 row_newbcast:10 row_mask:0xf bank_mask:0xf
  s_waitcnt vmcnt(5)
  v_lshlrev_b32 v28, 16, v168
  v_and_b32 v29, s31, v168
  v_lshlrev_b32 v30, 16, v169
  v_and_b32 v31, s31, v169
  v_lshlrev_b32 v32, 16, v170
  v_and_b32 v33, s31, v170
  v_lshlrev_b32 v34, 16, v171
  v_and_b32 v35, s31, v171
  v_pk_fma_f32 v[20:21], v[28:29], v[12:13], v[20:21] op_sel_hi:[1,0,1]
  v_pk_fma_f32 v[22:23], v[30:31], v[12:13], v[22:23] op_sel_hi:[1,0,1]
  v_pk_fma_f32 v[24:25], v[32:33], v[12:13], v[24:25] op_sel_hi:[1,0,1]
  v_pk_fma_f32 v[26:27], v[34:35], v[12:13], v[26:27] op_sel_hi:[1,0,1]
  v_mov_b32_dpp v12, v19 row_newbcast:11 row_mask:0xf bank_mask:0xf
  s_waitcnt vmcnt(4)
  v_lshlrev_b32 v28, 16, v172
  v_and_b32 v29, s31, v172
  v_lshlrev_b32 v30, 16, v173
  v_and_b32 v31, s31, v173
  v_lshlrev_b32 v32, 16, v174
  v_and_b32 v33, s31, v174
  v_lshlrev_b32 v34, 16, v175
  v_and_b32 v35, s31, v175
  v_pk_fma_f32 v[20:21], v[28:29], v[12:13], v[20:21] op_sel_hi:[1,0,1]
  v_pk_fma_f32 v[22:23], v[30:31], v[12:13], v[22:23] op_sel_hi:[1,0,1]
  v_pk_fma_f32 v[24:25], v[32:33], v[12:13], v[24:25] op_sel_hi:[1,0,1]
  v_pk_fma_f32 v[26:27], v[34:35], v[12:13], v[26:27] op_sel_hi:[1,0,1]
  v_mov_b32_dpp v12, v19 row_newbcast:12 row_mask:0xf bank_mask:0xf
  s_waitcnt vmcnt(3)
  v_lshlrev_b32 v28, 16, v176
  v_and_b32 v29, s31, v176
  v_lshlrev_b32 v30, 16, v177
  v_and_b32 v31, s31, v177
  v_lshlrev_b32 v32, 16, v178
  v_and_b32 v33, s31, v178
  v_lshlrev_b32 v34, 16, v179
  v_and_b32 v35, s31, v179
  v_pk_fma_f32 v[20:21], v[28:29], v[12:13], v[20:21] op_sel_hi:[1,0,1]
  v_pk_fma_f32 v[22:23], v[30:31], v[12:13], v[22:23] op_sel_hi:[1,0,1]
  v_pk_fma_f32 v[24:25], v[32:33], v[12:13], v[24:25] op_sel_hi:[1,0,1]
  v_pk_fma_f32 v[26:27], v[34:35], v[12:13], v[26:27] op_sel_hi:[1,0,1]
  v_mov_b32_dpp v12, v19 row_newbcast:13 row_mask:0xf bank_mask:0xf
  s_waitcnt vmcnt(2)
  v_lshlrev_b32 v28, 16, v180
  v_and_b32 v29, s31, v180
  v_lshlrev_b32 v30, 16, v181
  v_and_b32 v31, s31, v181
  v_lshlrev_b32 v32, 16, v182
  v_and_b32 v33, s31, v182
  v_lshlrev_b32 v34, 16, v183
  v_and_b32 v35, s31, v183
  v_pk_fma_f32 v[20:21], v[28:29], v[12:13], v[20:21] op_sel_hi:[1,0,1]
  v_pk_fma_f32 v[22:23], v[30:31], v[12:13], v[22:23] op_sel_hi:[1,0,1]
  v_pk_fma_f32 v[24:25], v[32:33], v[12:13], v[24:25] op_sel_hi:[1,0,1]
  v_pk_fma_f32 v[26:27], v[34:35], v[12:13], v[26:27] op_sel_hi:[1,0,1]
  v_mov_b32_dpp v12, v19 row_newbcast:14 row_mask:0xf bank_mask:0xf
  s_waitcnt vmcnt(1)
  v_lshlrev_b32 v28, 16, v184
  v_and_b32 v29, s31, v184
  v_lshlrev_b32 v30, 16, v185
  v_and_b32 v31, s31, v185
  v_lshlrev_b32 v32, 16, v186
  v_and_b32 v33, s31, v186
  v_lshlrev_b32 v34, 16, v187
  v_and_b32 v35, s31, v187
  v_pk_fma_f32 v[20:21], v[28:29], v[12:13], v[20:21] op_sel_hi:[1,0,1]
  v_pk_fma_f32 v[22:23], v[30:31], v[12:13], v[22:23] op_sel_hi:[1,0,1]
  v_pk_fma_f32 v[24:25], v[32:33], v[12:13], v[24:25] op_sel_hi:[1,0,1]
  v_pk_fma_f32 v[26:27], v[34:35], v[12:13], v[26:27] op_sel_hi:[1,0,1]
  v_mov_b32_dpp v12, v19 row_newbcast:15 row_mask:0xf bank_mask:0xf
  s_waitcnt vmcnt(0)
  v_lshlrev_b32 v28, 16, v188
  v_and_b32 v29, s31, v188
  v_lshlrev_b32 v30, 16, v189
  v_and_b32 v31, s31, v189
  v_lshlrev_b32 v32, 16, v190
  v_and_b32 v33, s31, v190
  v_lshlrev_b32 v34, 16, v191
  v_and_b32 v35, s31, v191
  v_pk_fma_f32 v[20:21], v[28:29], v[12:13], v[20:21] op_sel_hi:[1,0,1]
  v_pk_fma_f32 v[22:23], v[30:31], v[12:13], v[22:23] op_sel_hi:[1,0,1]
  v_pk_fma_f32 v[24:25], v[32:33], v[12:13], v[24:25] op_sel_hi:[1,0,1]
  v_pk_fma_f32 v[26:27], v[34:35], v[12:13], v[26:27] op_sel_hi:[1,0,1]
  s_nop 0
  v_permlane32_swap_b32 v20, v24
  v_permlane32_swap_b32 v21, v25
  v_permlane32_swap_b32 v22, v26
  v_permlane32_swap_b32 v23, v27
  v_add_f32 v20, v20, v24
  v_add_f32 v21, v21, v25
  v_add_f32 v22, v22, v26
  v_add_f32 v23, v23, v27
  s_nop 0
  v_permlane16_swap_b32 v20, v22
  v_permlane16_swap_b32 v21, v23
  v_add_f32 v20, v20, v22
  v_add_f32 v21, v21, v23
  s_lshl_b32 s27, s72, 9
  s_add_u32 s27, s27, 33280
  v_lshlrev_b32 v61, 1, v5
  v_add_u32 v61, s27, v61
  ds_write_b64 v61, v[20:21]
  s_lshl_b32 s27, s72, 2
  v_mov_b32 v61, s27
  v_mov_b32 v62, 1
  s_waitcnt lgkmcnt(0)
  ds_write_b32 v61, v62 offset:0
  s_setprio 0
  s_lshr_b32 s27, s2, 3
  s_and_b32 s28, s2, 7
  s_lshr_b32 s29, s28, 1
  s_mul_i32 s29, s29, 14
  s_add_u32 s26, s29, s27
  s_and_b32 s28, s28, 1
  s_lshl_b32 s28, s28, 8
  s_add_u32 s27, s27, s28
  s_cmp_ge_u32 s27, 14
  s_cselect_b32 s74, 0, 1
  s_cbranch_scc1 L1_noffn
  s_mov_b32 s60, s48
  s_mov_b32 s61, s49
  s_mov_b32 s62, 1835008
  s_mov_b32 s63, 0x00020000
  s_mov_b32 s64, s50
  s_mov_b32 s65, s51
  s_mov_b32 s66, 1835008
  s_mov_b32 s67, 0x00020000
  s_mul_i32 s27, s72, 458752
  s_lshl_b32 s28, s26, 6
  s_add_u32 s27, s27, s28
  s_mov_b32 s29, s27
  buffer_load_dwordx4 v[64:67], v4, s[60:63], s27 offen
  s_add_u32 s27, s27, 57344
  buffer_load_dwordx4 v[68:71], v4, s[60:63], s27 offen
  s_add_u32 s27, s27, 57344
  buffer_load_dwordx4 v[72:75], v4, s[60:63], s27 offen
  s_add_u32 s27, s27, 57344
  buffer_load_dwordx4 v[76:79], v4, s[60:63], s27 offen
  s_add_u32 s27, s27, 57344
  buffer_load_dwordx4 v[80:83], v4, s[60:63], s27 offen
  s_add_u32 s27, s27, 57344
  buffer_load_dwordx4 v[84:87], v4, s[60:63], s27 offen
  s_add_u32 s27, s27, 57344
  buffer_load_dwordx4 v[88:91], v4, s[60:63], s27 offen
  s_add_u32 s27, s27, 57344
  buffer_load_dwordx4 v[92:95], v4, s[60:63], s27 offen
  s_mov_b32 s27, s29
  buffer_load_dwordx4 v[96:99], v4, s[64:67], s27 offen
  s_add_u32 s27, s27, 57344
  buffer_load_dwordx4 v[100:103], v4, s[64:67], s27 offen
  s_add_u32 s27, s27, 57344
  buffer_load_dwordx4 v[104:107], v4, s[64:67], s27 offen
  s_add_u32 s27, s27, 57344
  buffer_load_dwordx4 v[108:111], v4, s[64:67], s27 offen
  s_add_u32 s27, s27, 57344
  buffer_load_dwordx4 v[112:115], v4, s[64:67], s27 offen
  s_add_u32 s27, s27, 57344
  buffer_load_dwordx4 v[116:119], v4, s[64:67], s27 offen
  s_add_u32 s27, s27, 57344
  buffer_load_dwordx4 v[120:123], v4, s[64:67], s27 offen
  s_add_u32 s27, s27, 57344
  buffer_load_dwordx4 v[124:127], v4, s[64:67], s27 offen
  s_mov_b32 s68, s52
  s_mov_b32 s69, s53
  s_mov_b32 s70, 1835008
  s_mov_b32 s71, 0x00020000
  s_lshl_b32 s27, s26, 15
  s_lshl_b32 s28, s72, 8
  s_add_u32 s27, s27, s28
  buffer_load_dwordx4 v[128:131], v3, s[68:71], s27 offen
  s_add_u32 s27, s27, 4096
  buffer_load_dwordx4 v[132:135], v3, s[68:71], s27 offen
  s_add_u32 s27, s27, 4096
  buffer_load_dwordx4 v[136:139], v3, s[68:71], s27 offen
  s_add_u32 s27, s27, 4096
  buffer_load_dwordx4 v[140:143], v3, s[68:71], s27 offen
  s_add_u32 s27, s27, 4096
  buffer_load_dwordx4 v[144:147], v3, s[68:71], s27 offen
  s_add_u32 s27, s27, 4096
  buffer_load_dwordx4 v[148:151], v3, s[68:71], s27 offen
  s_add_u32 s27, s27, 4096
  buffer_load_dwordx4 v[152:155], v3, s[68:71], s27 offen
  s_add_u32 s27, s27, 4096
  buffer_load_dwordx4 v[156:159], v3, s[68:71], s27 offen
  s_lshl_b32 s27, s72, 9
  v_lshrrev_b32 v61, 2, v1
  v_lshl_add_u32 v61, v61, 2, s27
  ds_read_b32 v224, v61 offset:4096
  ds_read_b32 v225, v61 offset:4160
  ds_read_b32 v226, v61 offset:4224
  ds_read_b32 v227, v61 offset:4288
  ds_read_b32 v228, v61 offset:4352
  ds_read_b32 v229, v61 offset:4416
  ds_read_b32 v230, v61 offset:4480
  ds_read_b32 v231, v61 offset:4544
  s_waitcnt lgkmcnt(0)
  ds_read_b32 v232, v61 offset:6144
  ds_read_b32 v233, v61 offset:6208
  ds_read_b32 v234, v61 offset:6272
  ds_read_b32 v235, v61 offset:6336
  ds_read_b32 v236, v61 offset:6400
  ds_read_b32 v237, v61 offset:6464
  ds_read_b32 v238, v61 offset:6528
  ds_read_b32 v239, v61 offset:6592
  s_waitcnt lgkmcnt(0)
  ds_read_b32 v240, v61 offset:8192
  ds_read_b32 v241, v61 offset:8256
  ds_read_b32 v242, v61 offset:8320
  ds_read_b32 v243, v61 offset:8384
  ds_read_b32 v244, v61 offset:8448
  ds_read_b32 v245, v61 offset:8512
  ds_read_b32 v246, v61 offset:8576
  ds_read_b32 v247, v61 offset:8640
  s_waitcnt lgkmcnt(0)
  ds_read_b32 v248, v61 offset:10240
  ds_read_b32 v249, v61 offset:10304
  ds_read_b32 v250, v61 offset:10368
  ds_read_b32 v251, v61 offset:10432
  ds_read_b32 v252, v61 offset:10496
  ds_read_b32 v253, v61 offset:10560
  ds_read_b32 v254, v61 offset:10624
  ds_read_b32 v255, v61 offset:10688
  s_waitcnt lgkmcnt(0)
  v_mov_b32 v160, 0
  v_mov_b32 v161, 0
  v_mov_b32 v162, 0
  v_mov_b32 v163, 0
  v_mov_b32 v164, 0
  v_mov_b32 v165, 0
  v_mov_b32 v166, 0
  v_mov_b32 v167, 0
  v_mov_b32 v168, 0
  v_mov_b32 v169, 0
  v_mov_b32 v170, 0
  v_mov_b32 v171, 0
  v_mov_b32 v172, 0
  v_mov_b32 v173, 0
  v_mov_b32 v174, 0
  v_mov_b32 v175, 0
  v_mov_b32 v176, 0
  v_mov_b32 v177, 0
  v_mov_b32 v178, 0
  v_mov_b32 v179, 0
  v_mov_b32 v180, 0
  v_mov_b32 v181, 0
  v_mov_b32 v182, 0
  v_mov_b32 v183, 0
  v_mov_b32 v184, 0
  v_mov_b32 v185, 0
  v_mov_b32 v186, 0
  v_mov_b32 v187, 0
  v_mov_b32 v188, 0
  v_mov_b32 v189, 0
  v_mov_b32 v190, 0
  v_mov_b32 v191, 0
  v_mov_b32 v192, 0
  v_mov_b32 v193, 0
  v_mov_b32 v194, 0
  v_mov_b32 v195, 0
  v_mov_b32 v196, 0
  v_mov_b32 v197, 0
  v_mov_b32 v198, 0
  v_mov_b32 v199, 0
  v_mov_b32 v200, 0
  v_mov_b32 v201, 0
  v_mov_b32 v202, 0
  v_mov_b32 v203, 0
  v_mov_b32 v204, 0
  v_mov_b32 v205, 0
  v_mov_b32 v206, 0
  v_mov_b32 v207, 0
  v_mov_b32 v208, 0
  v_mov_b32 v209, 0
  v_mov_b32 v210, 0
  v_mov_b32 v211, 0
  v_mov_b32 v212, 0
  v_mov_b32 v213, 0
  v_mov_b32 v214, 0
  v_mov_b32 v215, 0
  v_mov_b32 v216, 0
  v_mov_b32 v217, 0
  v_mov_b32 v218, 0
  v_mov_b32 v219, 0
  v_mov_b32 v220, 0
  v_mov_b32 v221, 0
  v_mov_b32 v222, 0
  v_mov_b32 v223, 0
  s_waitcnt vmcnt(23)
  v_lshlrev_b32 v28, 16, v64
  v_and_b32 v29, s31, v64
  v_lshlrev_b32 v30, 16, v65
  v_and_b32 v31, s31, v65
  v_lshlrev_b32 v32, 16, v66
  v_and_b32 v33, s31, v66
  v_lshlrev_b32 v34, 16, v67
  v_and_b32 v35, s31, v67
  v_pk_fma_f32 v[160:161], v[28:29], v[224:225], v[160:161] op_sel_hi:[1,0,1]
  v_pk_fma_f32 v[162:163], v[30:31], v[224:225], v[162:163] op_sel_hi:[1,0,1]
  v_pk_fma_f32 v[164:165], v[32:33], v[224:225], v[164:165] op_sel_hi:[1,0,1]
  v_pk_fma_f32 v[166:167], v[34:35], v[224:225], v[166:167] op_sel_hi:[1,0,1]
  v_pk_fma_f32 v[168:169], v[28:29], v[232:233], v[168:169] op_sel_hi:[1,0,1]
  v_pk_fma_f32 v[170:171], v[30:31], v[232:233], v[170:171] op_sel_hi:[1,0,1]
  v_pk_fma_f32 v[172:173], v[32:33], v[232:233], v[172:173] op_sel_hi:[1,0,1]
  v_pk_fma_f32 v[174:175], v[34:35], v[232:233], v[174:175] op_sel_hi:[1,0,1]
  v_pk_fma_f32 v[176:177], v[28:29], v[240:241], v[176:177] op_sel_hi:[1,0,1]
  v_pk_fma_f32 v[178:179], v[30:31], v[240:241], v[178:179] op_sel_hi:[1,0,1]
  v_pk_fma_f32 v[180:181], v[32:33], v[240:241], v[180:181] op_sel_hi:[1,0,1]
  v_pk_fma_f32 v[182:183], v[34:35], v[240:241], v[182:183] op_sel_hi:[1,0,1]
  v_pk_fma_f32 v[184:185], v[28:29], v[248:249], v[184:185] op_sel_hi:[1,0,1]
  v_pk_fma_f32 v[186:187], v[30:31], v[248:249], v[186:187] op_sel_hi:[1,0,1]
  v_pk_fma_f32 v[188:189], v[32:33], v[248:249], v[188:189] op_sel_hi:[1,0,1]
  v_pk_fma_f32 v[190:191], v[34:35], v[248:249], v[190:191] op_sel_hi:[1,0,1]
  s_waitcnt vmcnt(22)
  v_lshlrev_b32 v28, 16, v68
  v_and_b32 v29, s31, v68
  v_lshlrev_b32 v30, 16, v69
  v_and_b32 v31, s31, v69
  v_lshlrev_b32 v32, 16, v70
  v_and_b32 v33, s31, v70
  v_lshlrev_b32 v34, 16, v71
  v_and_b32 v35, s31, v71
  v_pk_fma_f32 v[160:161], v[28:29], v[224:225], v[160:161] op_sel:[0,1,0] op_sel_hi:[1,1,1]
  v_pk_fma_f32 v[162:163], v[30:31], v[224:225], v[162:163] op_sel:[0,1,0] op_sel_hi:[1,1,1]
  v_pk_fma_f32 v[164:165], v[32:33], v[224:225], v[164:165] op_sel:[0,1,0] op_sel_hi:[1,1,1]
  v_pk_fma_f32 v[166:167], v[34:35], v[224:225], v[166:167] op_sel:[0,1,0] op_sel_hi:[1,1,1]
  v_pk_fma_f32 v[168:169], v[28:29], v[232:233], v[168:169] op_sel:[0,1,0] op_sel_hi:[1,1,1]
  v_pk_fma_f32 v[170:171], v[30:31], v[232:233], v[170:171] op_sel:[0,1,0] op_sel_hi:[1,1,1]
  v_pk_fma_f32 v[172:173], v[32:33], v[232:233], v[172:173] op_sel:[0,1,0] op_sel_hi:[1,1,1]
  v_pk_fma_f32 v[174:175], v[34:35], v[232:233], v[174:175] op_sel:[0,1,0] op_sel_hi:[1,1,1]
  v_pk_fma_f32 v[176:177], v[28:29], v[240:241], v[176:177] op_sel:[0,1,0] op_sel_hi:[1,1,1]
  v_pk_fma_f32 v[178:179], v[30:31], v[240:241], v[178:179] op_sel:[0,1,0] op_sel_hi:[1,1,1]
  v_pk_fma_f32 v[180:181], v[32:33], v[240:241], v[180:181] op_sel:[0,1,0] op_sel_hi:[1,1,1]
  v_pk_fma_f32 v[182:183], v[34:35], v[240:241], v[182:183] op_sel:[0,1,0] op_sel_hi:[1,1,1]
  v_pk_fma_f32 v[184:185], v[28:29], v[248:249], v[184:185] op_sel:[0,1,0] op_sel_hi:[1,1,1]
  v_pk_fma_f32 v[186:187], v[30:31], v[248:249], v[186:187] op_sel:[0,1,0] op_sel_hi:[1,1,1]
  v_pk_fma_f32 v[188:189], v[32:33], v[248:249], v[188:189] op_sel:[0,1,0] op_sel_hi:[1,1,1]
  v_pk_fma_f32 v[190:191], v[34:35], v[248:249], v[190:191] op_sel:[0,1,0] op_sel_hi:[1,1,1]
  s_waitcnt vmcnt(21)
  v_lshlrev_b32 v28, 16, v72
  v_and_b32 v29, s31, v72
  v_lshlrev_b32 v30, 16, v73
  v_and_b32 v31, s31, v73
  v_lshlrev_b32 v32, 16, v74
  v_and_b32 v33, s31, v74
  v_lshlrev_b32 v34, 16, v75
  v_and_b32 v35, s31, v75
  v_pk_fma_f32 v[160:161], v[28:29], v[226:227], v[160:161] op_sel_hi:[1,0,1]
  v_pk_fma_f32 v[162:163], v[30:31], v[226:227], v[162:163] op_sel_hi:[1,0,1]
  v_pk_fma_f32 v[164:165], v[32:33], v[226:227], v[164:165] op_sel_hi:[1,0,1]
  v_pk_fma_f32 v[166:167], v[34:35], v[226:227], v[166:167] op_sel_hi:[1,0,1]
  v_pk_fma_f32 v[168:169], v[28:29], v[234:235], v[168:169] op_sel_hi:[1,0,1]
  v_pk_fma_f32 v[170:171], v[30:31], v[234:235], v[170:171] op_sel_hi:[1,0,1]
  v_pk_fma_f32 v[172:173], v[32:33], v[234:235], v[172:173] op_sel_hi:[1,0,1]
  v_pk_fma_f32 v[174:175], v[34:35], v[234:235], v[174:175] op_sel_hi:[1,0,1]
  v_pk_fma_f32 v[176:177], v[28:29], v[242:243], v[176:177] op_sel_hi:[1,0,1]
  v_pk_fma_f32 v[178:179], v[30:31], v[242:243], v[178:179] op_sel_hi:[1,0,1]
  v_pk_fma_f32 v[180:181], v[32:33], v[242:243], v[180:181] op_sel_hi:[1,0,1]
  v_pk_fma_f32 v[182:183], v[34:35], v[242:243], v[182:183] op_sel_hi:[1,0,1]
  v_pk_fma_f32 v[184:185], v[28:29], v[250:251], v[184:185] op_sel_hi:[1,0,1]
  v_pk_fma_f32 v[186:187], v[30:31], v[250:251], v[186:187] op_sel_hi:[1,0,1]
  v_pk_fma_f32 v[188:189], v[32:33], v[250:251], v[188:189] op_sel_hi:[1,0,1]
  v_pk_fma_f32 v[190:191], v[34:35], v[250:251], v[190:191] op_sel_hi:[1,0,1]
  s_waitcnt vmcnt(20)
  v_lshlrev_b32 v28, 16, v76
  v_and_b32 v29, s31, v76
  v_lshlrev_b32 v30, 16, v77
  v_and_b32 v31, s31, v77
  v_lshlrev_b32 v32, 16, v78
  v_and_b32 v33, s31, v78
  v_lshlrev_b32 v34, 16, v79
  v_and_b32 v35, s31, v79
  v_pk_fma_f32 v[160:161], v[28:29], v[226:227], v[160:161] op_sel:[0,1,0] op_sel_hi:[1,1,1]
  v_pk_fma_f32 v[162:163], v[30:31], v[226:227], v[162:163] op_sel:[0,1,0] op_sel_hi:[1,1,1]
  v_pk_fma_f32 v[164:165], v[32:33], v[226:227], v[164:165] op_sel:[0,1,0] op_sel_hi:[1,1,1]
  v_pk_fma_f32 v[166:167], v[34:35], v[226:227], v[166:167] op_sel:[0,1,0] op_sel_hi:[1,1,1]
  v_pk_fma_f32 v[168:169], v[28:29], v[234:235], v[168:169] op_sel:[0,1,0] op_sel_hi:[1,1,1]
  v_pk_fma_f32 v[170:171], v[30:31], v[234:235], v[170:171] op_sel:[0,1,0] op_sel_hi:[1,1,1]
  v_pk_fma_f32 v[172:173], v[32:33], v[234:235], v[172:173] op_sel:[0,1,0] op_sel_hi:[1,1,1]
  v_pk_fma_f32 v[174:175], v[34:35], v[234:235], v[174:175] op_sel:[0,1,0] op_sel_hi:[1,1,1]
  v_pk_fma_f32 v[176:177], v[28:29], v[242:243], v[176:177] op_sel:[0,1,0] op_sel_hi:[1,1,1]
  v_pk_fma_f32 v[178:179], v[30:31], v[242:243], v[178:179] op_sel:[0,1,0] op_sel_hi:[1,1,1]
  v_pk_fma_f32 v[180:181], v[32:33], v[242:243], v[180:181] op_sel:[0,1,0] op_sel_hi:[1,1,1]
  v_pk_fma_f32 v[182:183], v[34:35], v[242:243], v[182:183] op_sel:[0,1,0] op_sel_hi:[1,1,1]
  v_pk_fma_f32 v[184:185], v[28:29], v[250:251], v[184:185] op_sel:[0,1,0] op_sel_hi:[1,1,1]
  v_pk_fma_f32 v[186:187], v[30:31], v[250:251], v[186:187] op_sel:[0,1,0] op_sel_hi:[1,1,1]
  v_pk_fma_f32 v[188:189], v[32:33], v[250:251], v[188:189] op_sel:[0,1,0] op_sel_hi:[1,1,1]
  v_pk_fma_f32 v[190:191], v[34:35], v[250:251], v[190:191] op_sel:[0,1,0] op_sel_hi:[1,1,1]
  s_waitcnt vmcnt(19)
  v_lshlrev_b32 v28, 16, v80
  v_and_b32 v29, s31, v80
  v_lshlrev_b32 v30, 16, v81
  v_and_b32 v31, s31, v81
  v_lshlrev_b32 v32, 16, v82
  v_and_b32 v33, s31, v82
  v_lshlrev_b32 v34, 16, v83
  v_and_b32 v35, s31, v83
  v_pk_fma_f32 v[160:161], v[28:29], v[228:229], v[160:161] op_sel_hi:[1,0,1]
  v_pk_fma_f32 v[162:163], v[30:31], v[228:229], v[162:163] op_sel_hi:[1,0,1]
  v_pk_fma_f32 v[164:165], v[32:33], v[228:229], v[164:165] op_sel_hi:[1,0,1]
  v_pk_fma_f32 v[166:167], v[34:35], v[228:229], v[166:167] op_sel_hi:[1,0,1]
  v_pk_fma_f32 v[168:169], v[28:29], v[236:237], v[168:169] op_sel_hi:[1,0,1]
  v_pk_fma_f32 v[170:171], v[30:31], v[236:237], v[170:171] op_sel_hi:[1,0,1]
  v_pk_fma_f32 v[172:173], v[32:33], v[236:237], v[172:173] op_sel_hi:[1,0,1]
  v_pk_fma_f32 v[174:175], v[34:35], v[236:237], v[174:175] op_sel_hi:[1,0,1]
  v_pk_fma_f32 v[176:177], v[28:29], v[244:245], v[176:177] op_sel_hi:[1,0,1]
  v_pk_fma_f32 v[178:179], v[30:31], v[244:245], v[178:179] op_sel_hi:[1,0,1]
  v_pk_fma_f32 v[180:181], v[32:33], v[244:245], v[180:181] op_sel_hi:[1,0,1]
  v_pk_fma_f32 v[182:183], v[34:35], v[244:245], v[182:183] op_sel_hi:[1,0,1]
  v_pk_fma_f32 v[184:185], v[28:29], v[252:253], v[184:185] op_sel_hi:[1,0,1]
  v_pk_fma_f32 v[186:187], v[30:31], v[252:253], v[186:187] op_sel_hi:[1,0,1]
  v_pk_fma_f32 v[188:189], v[32:33], v[252:253], v[188:189] op_sel_hi:[1,0,1]
  v_pk_fma_f32 v[190:191], v[34:35], v[252:253], v[190:191] op_sel_hi:[1,0,1]
  s_waitcnt vmcnt(18)
  v_lshlrev_b32 v28, 16, v84
  v_and_b32 v29, s31, v84
  v_lshlrev_b32 v30, 16, v85
  v_and_b32 v31, s31, v85
  v_lshlrev_b32 v32, 16, v86
  v_and_b32 v33, s31, v86
  v_lshlrev_b32 v34, 16, v87
  v_and_b32 v35, s31, v87
  v_pk_fma_f32 v[160:161], v[28:29], v[228:229], v[160:161] op_sel:[0,1,0] op_sel_hi:[1,1,1]
  v_pk_fma_f32 v[162:163], v[30:31], v[228:229], v[162:163] op_sel:[0,1,0] op_sel_hi:[1,1,1]
  v_pk_fma_f32 v[164:165], v[32:33], v[228:229], v[164:165] op_sel:[0,1,0] op_sel_hi:[1,1,1]
  v_pk_fma_f32 v[166:167], v[34:35], v[228:229], v[166:167] op_sel:[0,1,0] op_sel_hi:[1,1,1]
  v_pk_fma_f32 v[168:169], v[28:29], v[236:237], v[168:169] op_sel:[0,1,0] op_sel_hi:[1,1,1]
  v_pk_fma_f32 v[170:171], v[30:31], v[236:237], v[170:171] op_sel:[0,1,0] op_sel_hi:[1,1,1]
  v_pk_fma_f32 v[172:173], v[32:33], v[236:237], v[172:173] op_sel:[0,1,0] op_sel_hi:[1,1,1]
  v_pk_fma_f32 v[174:175], v[34:35], v[236:237], v[174:175] op_sel:[0,1,0] op_sel_hi:[1,1,1]
  v_pk_fma_f32 v[176:177], v[28:29], v[244:245], v[176:177] op_sel:[0,1,0] op_sel_hi:[1,1,1]
  v_pk_fma_f32 v[178:179], v[30:31], v[244:245], v[178:179] op_sel:[0,1,0] op_sel_hi:[1,1,1]
  v_pk_fma_f32 v[180:181], v[32:33], v[244:245], v[180:181] op_sel:[0,1,0] op_sel_hi:[1,1,1]
  v_pk_fma_f32 v[182:183], v[34:35], v[244:245], v[182:183] op_sel:[0,1,0] op_sel_hi:[1,1,1]
  v_pk_fma_f32 v[184:185], v[28:29], v[252:253], v[184:185] op_sel:[0,1,0] op_sel_hi:[1,1,1]
  v_pk_fma_f32 v[186:187], v[30:31], v[252:253], v[186:187] op_sel:[0,1,0] op_sel_hi:[1,1,1]
  v_pk_fma_f32 v[188:189], v[32:33], v[252:253], v[188:189] op_sel:[0,1,0] op_sel_hi:[1,1,1]
  v_pk_fma_f32 v[190:191], v[34:35], v[252:253], v[190:191] op_sel:[0,1,0] op_sel_hi:[1,1,1]
  s_waitcnt vmcnt(17)
  v_lshlrev_b32 v28, 16, v88
  v_and_b32 v29, s31, v88
  v_lshlrev_b32 v30, 16, v89
  v_and_b32 v31, s31, v89
  v_lshlrev_b32 v32, 16, v90
  v_and_b32 v33, s31, v90
  v_lshlrev_b32 v34, 16, v91
  v_and_b32 v35, s31, v91
  v_pk_fma_f32 v[160:161], v[28:29], v[230:231], v[160:161] op_sel_hi:[1,0,1]
  v_pk_fma_f32 v[162:163], v[30:31], v[230:231], v[162:163] op_sel_hi:[1,0,1]
  v_pk_fma_f32 v[164:165], v[32:33], v[230:231], v[164:165] op_sel_hi:[1,0,1]
  v_pk_fma_f32 v[166:167], v[34:35], v[230:231], v[166:167] op_sel_hi:[1,0,1]
  v_pk_fma_f32 v[168:169], v[28:29], v[238:239], v[168:169] op_sel_hi:[1,0,1]
  v_pk_fma_f32 v[170:171], v[30:31], v[238:239], v[170:171] op_sel_hi:[1,0,1]
  v_pk_fma_f32 v[172:173], v[32:33], v[238:239], v[172:173] op_sel_hi:[1,0,1]
  v_pk_fma_f32 v[174:175], v[34:35], v[238:239], v[174:175] op_sel_hi:[1,0,1]
  v_pk_fma_f32 v[176:177], v[28:29], v[246:247], v[176:177] op_sel_hi:[1,0,1]
  v_pk_fma_f32 v[178:179], v[30:31], v[246:247], v[178:179] op_sel_hi:[1,0,1]
  v_pk_fma_f32 v[180:181], v[32:33], v[246:247], v[180:181] op_sel_hi:[1,0,1]
  v_pk_fma_f32 v[182:183], v[34:35], v[246:247], v[182:183] op_sel_hi:[1,0,1]
  v_pk_fma_f32 v[184:185], v[28:29], v[254:255], v[184:185] op_sel_hi:[1,0,1]
  v_pk_fma_f32 v[186:187], v[30:31], v[254:255], v[186:187] op_sel_hi:[1,0,1]
  v_pk_fma_f32 v[188:189], v[32:33], v[254:255], v[188:189] op_sel_hi:[1,0,1]
  v_pk_fma_f32 v[190:191], v[34:35], v[254:255], v[190:191] op_sel_hi:[1,0,1]
  s_waitcnt vmcnt(16)
  v_lshlrev_b32 v28, 16, v92
  v_and_b32 v29, s31, v92
  v_lshlrev_b32 v30, 16, v93
  v_and_b32 v31, s31, v93
  v_lshlrev_b32 v32, 16, v94
  v_and_b32 v33, s31, v94
  v_lshlrev_b32 v34, 16, v95
  v_and_b32 v35, s31, v95
  v_pk_fma_f32 v[160:161], v[28:29], v[230:231], v[160:161] op_sel:[0,1,0] op_sel_hi:[1,1,1]
  v_pk_fma_f32 v[162:163], v[30:31], v[230:231], v[162:163] op_sel:[0,1,0] op_sel_hi:[1,1,1]
  v_pk_fma_f32 v[164:165], v[32:33], v[230:231], v[164:165] op_sel:[0,1,0] op_sel_hi:[1,1,1]
  v_pk_fma_f32 v[166:167], v[34:35], v[230:231], v[166:167] op_sel:[0,1,0] op_sel_hi:[1,1,1]
  v_pk_fma_f32 v[168:169], v[28:29], v[238:239], v[168:169] op_sel:[0,1,0] op_sel_hi:[1,1,1]
  v_pk_fma_f32 v[170:171], v[30:31], v[238:239], v[170:171] op_sel:[0,1,0] op_sel_hi:[1,1,1]
  v_pk_fma_f32 v[172:173], v[32:33], v[238:239], v[172:173] op_sel:[0,1,0] op_sel_hi:[1,1,1]
  v_pk_fma_f32 v[174:175], v[34:35], v[238:239], v[174:175] op_sel:[0,1,0] op_sel_hi:[1,1,1]
  v_pk_fma_f32 v[176:177], v[28:29], v[246:247], v[176:177] op_sel:[0,1,0] op_sel_hi:[1,1,1]
  v_pk_fma_f32 v[178:179], v[30:31], v[246:247], v[178:179] op_sel:[0,1,0] op_sel_hi:[1,1,1]
  v_pk_fma_f32 v[180:181], v[32:33], v[246:247], v[180:181] op_sel:[0,1,0] op_sel_hi:[1,1,1]
  v_pk_fma_f32 v[182:183], v[34:35], v[246:247], v[182:183] op_sel:[0,1,0] op_sel_hi:[1,1,1]
  v_pk_fma_f32 v[184:185], v[28:29], v[254:255], v[184:185] op_sel:[0,1,0] op_sel_hi:[1,1,1]
  v_pk_fma_f32 v[186:187], v[30:31], v[254:255], v[186:187] op_sel:[0,1,0] op_sel_hi:[1,1,1]
  v_pk_fma_f32 v[188:189], v[32:33], v[254:255], v[188:189] op_sel:[0,1,0] op_sel_hi:[1,1,1]
  v_pk_fma_f32 v[190:191], v[34:35], v[254:255], v[190:191] op_sel:[0,1,0] op_sel_hi:[1,1,1]
  s_waitcnt vmcnt(15)
  v_lshlrev_b32 v28, 16, v96
  v_and_b32 v29, s31, v96
  v_lshlrev_b32 v30, 16, v97
  v_and_b32 v31, s31, v97
  v_lshlrev_b32 v32, 16, v98
  v_and_b32 v33, s31, v98
  v_lshlrev_b32 v34, 16, v99
  v_and_b32 v35, s31, v99
  v_pk_fma_f32 v[192:193], v[28:29], v[224:225], v[192:193] op_sel_hi:[1,0,1]
  v_pk_fma_f32 v[194:195], v[30:31], v[224:225], v[194:195] op_sel_hi:[1,0,1]
  v_pk_fma_f32 v[196:197], v[32:33], v[224:225], v[196:197] op_sel_hi:[1,0,1]
  v_pk_fma_f32 v[198:199], v[34:35], v[224:225], v[198:199] op_sel_hi:[1,0,1]
  v_pk_fma_f32 v[200:201], v[28:29], v[232:233], v[200:201] op_sel_hi:[1,0,1]
  v_pk_fma_f32 v[202:203], v[30:31], v[232:233], v[202:203] op_sel_hi:[1,0,1]
  v_pk_fma_f32 v[204:205], v[32:33], v[232:233], v[204:205] op_sel_hi:[1,0,1]
  v_pk_fma_f32 v[206:207], v[34:35], v[232:233], v[206:207] op_sel_hi:[1,0,1]
  v_pk_fma_f32 v[208:209], v[28:29], v[240:241], v[208:209] op_sel_hi:[1,0,1]
  v_pk_fma_f32 v[210:211], v[30:31], v[240:241], v[210:211] op_sel_hi:[1,0,1]
  v_pk_fma_f32 v[212:213], v[32:33], v[240:241], v[212:213] op_sel_hi:[1,0,1]
  v_pk_fma_f32 v[214:215], v[34:35], v[240:241], v[214:215] op_sel_hi:[1,0,1]
  v_pk_fma_f32 v[216:217], v[28:29], v[248:249], v[216:217] op_sel_hi:[1,0,1]
  v_pk_fma_f32 v[218:219], v[30:31], v[248:249], v[218:219] op_sel_hi:[1,0,1]
  v_pk_fma_f32 v[220:221], v[32:33], v[248:249], v[220:221] op_sel_hi:[1,0,1]
  v_pk_fma_f32 v[222:223], v[34:35], v[248:249], v[222:223] op_sel_hi:[1,0,1]
  s_waitcnt vmcnt(14)
  v_lshlrev_b32 v28, 16, v100
  v_and_b32 v29, s31, v100
  v_lshlrev_b32 v30, 16, v101
  v_and_b32 v31, s31, v101
  v_lshlrev_b32 v32, 16, v102
  v_and_b32 v33, s31, v102
  v_lshlrev_b32 v34, 16, v103
  v_and_b32 v35, s31, v103
  v_pk_fma_f32 v[192:193], v[28:29], v[224:225], v[192:193] op_sel:[0,1,0] op_sel_hi:[1,1,1]
  v_pk_fma_f32 v[194:195], v[30:31], v[224:225], v[194:195] op_sel:[0,1,0] op_sel_hi:[1,1,1]
  v_pk_fma_f32 v[196:197], v[32:33], v[224:225], v[196:197] op_sel:[0,1,0] op_sel_hi:[1,1,1]
  v_pk_fma_f32 v[198:199], v[34:35], v[224:225], v[198:199] op_sel:[0,1,0] op_sel_hi:[1,1,1]
  v_pk_fma_f32 v[200:201], v[28:29], v[232:233], v[200:201] op_sel:[0,1,0] op_sel_hi:[1,1,1]
  v_pk_fma_f32 v[202:203], v[30:31], v[232:233], v[202:203] op_sel:[0,1,0] op_sel_hi:[1,1,1]
  v_pk_fma_f32 v[204:205], v[32:33], v[232:233], v[204:205] op_sel:[0,1,0] op_sel_hi:[1,1,1]
  v_pk_fma_f32 v[206:207], v[34:35], v[232:233], v[206:207] op_sel:[0,1,0] op_sel_hi:[1,1,1]
  v_pk_fma_f32 v[208:209], v[28:29], v[240:241], v[208:209] op_sel:[0,1,0] op_sel_hi:[1,1,1]
  v_pk_fma_f32 v[210:211], v[30:31], v[240:241], v[210:211] op_sel:[0,1,0] op_sel_hi:[1,1,1]
  v_pk_fma_f32 v[212:213], v[32:33], v[240:241], v[212:213] op_sel:[0,1,0] op_sel_hi:[1,1,1]
  v_pk_fma_f32 v[214:215], v[34:35], v[240:241], v[214:215] op_sel:[0,1,0] op_sel_hi:[1,1,1]
  v_pk_fma_f32 v[216:217], v[28:29], v[248:249], v[216:217] op_sel:[0,1,0] op_sel_hi:[1,1,1]
  v_pk_fma_f32 v[218:219], v[30:31], v[248:249], v[218:219] op_sel:[0,1,0] op_sel_hi:[1,1,1]
  v_pk_fma_f32 v[220:221], v[32:33], v[248:249], v[220:221] op_sel:[0,1,0] op_sel_hi:[1,1,1]
  v_pk_fma_f32 v[222:223], v[34:35], v[248:249], v[222:223] op_sel:[0,1,0] op_sel_hi:[1,1,1]
  s_waitcnt vmcnt(13)
  v_lshlrev_b32 v28, 16, v104
  v_and_b32 v29, s31, v104
  v_lshlrev_b32 v30, 16, v105
  v_and_b32 v31, s31, v105
  v_lshlrev_b32 v32, 16, v106
  v_and_b32 v33, s31, v106
  v_lshlrev_b32 v34, 16, v107
  v_and_b32 v35, s31, v107
  v_pk_fma_f32 v[192:193], v[28:29], v[226:227], v[192:193] op_sel_hi:[1,0,1]
  v_pk_fma_f32 v[194:195], v[30:31], v[226:227], v[194:195] op_sel_hi:[1,0,1]
  v_pk_fma_f32 v[196:197], v[32:33], v[226:227], v[196:197] op_sel_hi:[1,0,1]
  v_pk_fma_f32 v[198:199], v[34:35], v[226:227], v[198:199] op_sel_hi:[1,0,1]
  v_pk_fma_f32 v[200:201], v[28:29], v[234:235], v[200:201] op_sel_hi:[1,0,1]
  v_pk_fma_f32 v[202:203], v[30:31], v[234:235], v[202:203] op_sel_hi:[1,0,1]
  v_pk_fma_f32 v[204:205], v[32:33], v[234:235], v[204:205] op_sel_hi:[1,0,1]
  v_pk_fma_f32 v[206:207], v[34:35], v[234:235], v[206:207] op_sel_hi:[1,0,1]
  v_pk_fma_f32 v[208:209], v[28:29], v[242:243], v[208:209] op_sel_hi:[1,0,1]
  v_pk_fma_f32 v[210:211], v[30:31], v[242:243], v[210:211] op_sel_hi:[1,0,1]
  v_pk_fma_f32 v[212:213], v[32:33], v[242:243], v[212:213] op_sel_hi:[1,0,1]
  v_pk_fma_f32 v[214:215], v[34:35], v[242:243], v[214:215] op_sel_hi:[1,0,1]
  v_pk_fma_f32 v[216:217], v[28:29], v[250:251], v[216:217] op_sel_hi:[1,0,1]
  v_pk_fma_f32 v[218:219], v[30:31], v[250:251], v[218:219] op_sel_hi:[1,0,1]
  v_pk_fma_f32 v[220:221], v[32:33], v[250:251], v[220:221] op_sel_hi:[1,0,1]
  v_pk_fma_f32 v[222:223], v[34:35], v[250:251], v[222:223] op_sel_hi:[1,0,1]
  s_waitcnt vmcnt(12)
  v_lshlrev_b32 v28, 16, v108
  v_and_b32 v29, s31, v108
  v_lshlrev_b32 v30, 16, v109
  v_and_b32 v31, s31, v109
  v_lshlrev_b32 v32, 16, v110
  v_and_b32 v33, s31, v110
  v_lshlrev_b32 v34, 16, v111
  v_and_b32 v35, s31, v111
  v_pk_fma_f32 v[192:193], v[28:29], v[226:227], v[192:193] op_sel:[0,1,0] op_sel_hi:[1,1,1]
  v_pk_fma_f32 v[194:195], v[30:31], v[226:227], v[194:195] op_sel:[0,1,0] op_sel_hi:[1,1,1]
  v_pk_fma_f32 v[196:197], v[32:33], v[226:227], v[196:197] op_sel:[0,1,0] op_sel_hi:[1,1,1]
  v_pk_fma_f32 v[198:199], v[34:35], v[226:227], v[198:199] op_sel:[0,1,0] op_sel_hi:[1,1,1]
  v_pk_fma_f32 v[200:201], v[28:29], v[234:235], v[200:201] op_sel:[0,1,0] op_sel_hi:[1,1,1]
  v_pk_fma_f32 v[202:203], v[30:31], v[234:235], v[202:203] op_sel:[0,1,0] op_sel_hi:[1,1,1]
  v_pk_fma_f32 v[204:205], v[32:33], v[234:235], v[204:205] op_sel:[0,1,0] op_sel_hi:[1,1,1]
  v_pk_fma_f32 v[206:207], v[34:35], v[234:235], v[206:207] op_sel:[0,1,0] op_sel_hi:[1,1,1]
  v_pk_fma_f32 v[208:209], v[28:29], v[242:243], v[208:209] op_sel:[0,1,0] op_sel_hi:[1,1,1]
  v_pk_fma_f32 v[210:211], v[30:31], v[242:243], v[210:211] op_sel:[0,1,0] op_sel_hi:[1,1,1]
  v_pk_fma_f32 v[212:213], v[32:33], v[242:243], v[212:213] op_sel:[0,1,0] op_sel_hi:[1,1,1]
  v_pk_fma_f32 v[214:215], v[34:35], v[242:243], v[214:215] op_sel:[0,1,0] op_sel_hi:[1,1,1]
  v_pk_fma_f32 v[216:217], v[28:29], v[250:251], v[216:217] op_sel:[0,1,0] op_sel_hi:[1,1,1]
  v_pk_fma_f32 v[218:219], v[30:31], v[250:251], v[218:219] op_sel:[0,1,0] op_sel_hi:[1,1,1]
  v_pk_fma_f32 v[220:221], v[32:33], v[250:251], v[220:221] op_sel:[0,1,0] op_sel_hi:[1,1,1]
  v_pk_fma_f32 v[222:223], v[34:35], v[250:251], v[222:223] op_sel:[0,1,0] op_sel_hi:[1,1,1]
  s_waitcnt vmcnt(11)
  v_lshlrev_b32 v28, 16, v112
  v_and_b32 v29, s31, v112
  v_lshlrev_b32 v30, 16, v113
  v_and_b32 v31, s31, v113
  v_lshlrev_b32 v32, 16, v114
  v_and_b32 v33, s31, v114
  v_lshlrev_b32 v34, 16, v115
  v_and_b32 v35, s31, v115
  v_pk_fma_f32 v[192:193], v[28:29], v[228:229], v[192:193] op_sel_hi:[1,0,1]
  v_pk_fma_f32 v[194:195], v[30:31], v[228:229], v[194:195] op_sel_hi:[1,0,1]
  v_pk_fma_f32 v[196:197], v[32:33], v[228:229], v[196:197] op_sel_hi:[1,0,1]
  v_pk_fma_f32 v[198:199], v[34:35], v[228:229], v[198:199] op_sel_hi:[1,0,1]
  v_pk_fma_f32 v[200:201], v[28:29], v[236:237], v[200:201] op_sel_hi:[1,0,1]
  v_pk_fma_f32 v[202:203], v[30:31], v[236:237], v[202:203] op_sel_hi:[1,0,1]
  v_pk_fma_f32 v[204:205], v[32:33], v[236:237], v[204:205] op_sel_hi:[1,0,1]
  v_pk_fma_f32 v[206:207], v[34:35], v[236:237], v[206:207] op_sel_hi:[1,0,1]
  v_pk_fma_f32 v[208:209], v[28:29], v[244:245], v[208:209] op_sel_hi:[1,0,1]
  v_pk_fma_f32 v[210:211], v[30:31], v[244:245], v[210:211] op_sel_hi:[1,0,1]
  v_pk_fma_f32 v[212:213], v[32:33], v[244:245], v[212:213] op_sel_hi:[1,0,1]
  v_pk_fma_f32 v[214:215], v[34:35], v[244:245], v[214:215] op_sel_hi:[1,0,1]
  v_pk_fma_f32 v[216:217], v[28:29], v[252:253], v[216:217] op_sel_hi:[1,0,1]
  v_pk_fma_f32 v[218:219], v[30:31], v[252:253], v[218:219] op_sel_hi:[1,0,1]
  v_pk_fma_f32 v[220:221], v[32:33], v[252:253], v[220:221] op_sel_hi:[1,0,1]
  v_pk_fma_f32 v[222:223], v[34:35], v[252:253], v[222:223] op_sel_hi:[1,0,1]
  s_waitcnt vmcnt(10)
  v_lshlrev_b32 v28, 16, v116
  v_and_b32 v29, s31, v116
  v_lshlrev_b32 v30, 16, v117
  v_and_b32 v31, s31, v117
  v_lshlrev_b32 v32, 16, v118
  v_and_b32 v33, s31, v118
  v_lshlrev_b32 v34, 16, v119
  v_and_b32 v35, s31, v119
  v_pk_fma_f32 v[192:193], v[28:29], v[228:229], v[192:193] op_sel:[0,1,0] op_sel_hi:[1,1,1]
  v_pk_fma_f32 v[194:195], v[30:31], v[228:229], v[194:195] op_sel:[0,1,0] op_sel_hi:[1,1,1]
  v_pk_fma_f32 v[196:197], v[32:33], v[228:229], v[196:197] op_sel:[0,1,0] op_sel_hi:[1,1,1]
  v_pk_fma_f32 v[198:199], v[34:35], v[228:229], v[198:199] op_sel:[0,1,0] op_sel_hi:[1,1,1]
  v_pk_fma_f32 v[200:201], v[28:29], v[236:237], v[200:201] op_sel:[0,1,0] op_sel_hi:[1,1,1]
  v_pk_fma_f32 v[202:203], v[30:31], v[236:237], v[202:203] op_sel:[0,1,0] op_sel_hi:[1,1,1]
  v_pk_fma_f32 v[204:205], v[32:33], v[236:237], v[204:205] op_sel:[0,1,0] op_sel_hi:[1,1,1]
  v_pk_fma_f32 v[206:207], v[34:35], v[236:237], v[206:207] op_sel:[0,1,0] op_sel_hi:[1,1,1]
  v_pk_fma_f32 v[208:209], v[28:29], v[244:245], v[208:209] op_sel:[0,1,0] op_sel_hi:[1,1,1]
  v_pk_fma_f32 v[210:211], v[30:31], v[244:245], v[210:211] op_sel:[0,1,0] op_sel_hi:[1,1,1]
  v_pk_fma_f32 v[212:213], v[32:33], v[244:245], v[212:213] op_sel:[0,1,0] op_sel_hi:[1,1,1]
  v_pk_fma_f32 v[214:215], v[34:35], v[244:245], v[214:215] op_sel:[0,1,0] op_sel_hi:[1,1,1]
  v_pk_fma_f32 v[216:217], v[28:29], v[252:253], v[216:217] op_sel:[0,1,0] op_sel_hi:[1,1,1]
  v_pk_fma_f32 v[218:219], v[30:31], v[252:253], v[218:219] op_sel:[0,1,0] op_sel_hi:[1,1,1]
  v_pk_fma_f32 v[220:221], v[32:33], v[252:253], v[220:221] op_sel:[0,1,0] op_sel_hi:[1,1,1]
  v_pk_fma_f32 v[222:223], v[34:35], v[252:253], v[222:223] op_sel:[0,1,0] op_sel_hi:[1,1,1]
  s_waitcnt vmcnt(9)
  v_lshlrev_b32 v28, 16, v120
  v_and_b32 v29, s31, v120
  v_lshlrev_b32 v30, 16, v121
  v_and_b32 v31, s31, v121
  v_lshlrev_b32 v32, 16, v122
  v_and_b32 v33, s31, v122
  v_lshlrev_b32 v34, 16, v123
  v_and_b32 v35, s31, v123
  v_pk_fma_f32 v[192:193], v[28:29], v[230:231], v[192:193] op_sel_hi:[1,0,1]
  v_pk_fma_f32 v[194:195], v[30:31], v[230:231], v[194:195] op_sel_hi:[1,0,1]
  v_pk_fma_f32 v[196:197], v[32:33], v[230:231], v[196:197] op_sel_hi:[1,0,1]
  v_pk_fma_f32 v[198:199], v[34:35], v[230:231], v[198:199] op_sel_hi:[1,0,1]
  v_pk_fma_f32 v[200:201], v[28:29], v[238:239], v[200:201] op_sel_hi:[1,0,1]
  v_pk_fma_f32 v[202:203], v[30:31], v[238:239], v[202:203] op_sel_hi:[1,0,1]
  v_pk_fma_f32 v[204:205], v[32:33], v[238:239], v[204:205] op_sel_hi:[1,0,1]
  v_pk_fma_f32 v[206:207], v[34:35], v[238:239], v[206:207] op_sel_hi:[1,0,1]
  v_pk_fma_f32 v[208:209], v[28:29], v[246:247], v[208:209] op_sel_hi:[1,0,1]
  v_pk_fma_f32 v[210:211], v[30:31], v[246:247], v[210:211] op_sel_hi:[1,0,1]
  v_pk_fma_f32 v[212:213], v[32:33], v[246:247], v[212:213] op_sel_hi:[1,0,1]
  v_pk_fma_f32 v[214:215], v[34:35], v[246:247], v[214:215] op_sel_hi:[1,0,1]
  v_pk_fma_f32 v[216:217], v[28:29], v[254:255], v[216:217] op_sel_hi:[1,0,1]
  v_pk_fma_f32 v[218:219], v[30:31], v[254:255], v[218:219] op_sel_hi:[1,0,1]
  v_pk_fma_f32 v[220:221], v[32:33], v[254:255], v[220:221] op_sel_hi:[1,0,1]
  v_pk_fma_f32 v[222:223], v[34:35], v[254:255], v[222:223] op_sel_hi:[1,0,1]
  s_waitcnt vmcnt(8)
  v_lshlrev_b32 v28, 16, v124
  v_and_b32 v29, s31, v124
  v_lshlrev_b32 v30, 16, v125
  v_and_b32 v31, s31, v125
  v_lshlrev_b32 v32, 16, v126
  v_and_b32 v33, s31, v126
  v_lshlrev_b32 v34, 16, v127
  v_and_b32 v35, s31, v127
  v_pk_fma_f32 v[192:193], v[28:29], v[230:231], v[192:193] op_sel:[0,1,0] op_sel_hi:[1,1,1]
  v_pk_fma_f32 v[194:195], v[30:31], v[230:231], v[194:195] op_sel:[0,1,0] op_sel_hi:[1,1,1]
  v_pk_fma_f32 v[196:197], v[32:33], v[230:231], v[196:197] op_sel:[0,1,0] op_sel_hi:[1,1,1]
  v_pk_fma_f32 v[198:199], v[34:35], v[230:231], v[198:199] op_sel:[0,1,0] op_sel_hi:[1,1,1]
  v_pk_fma_f32 v[200:201], v[28:29], v[238:239], v[200:201] op_sel:[0,1,0] op_sel_hi:[1,1,1]
  v_pk_fma_f32 v[202:203], v[30:31], v[238:239], v[202:203] op_sel:[0,1,0] op_sel_hi:[1,1,1]
  v_pk_fma_f32 v[204:205], v[32:33], v[238:239], v[204:205] op_sel:[0,1,0] op_sel_hi:[1,1,1]
  v_pk_fma_f32 v[206:207], v[34:35], v[238:239], v[206:207] op_sel:[0,1,0] op_sel_hi:[1,1,1]
  v_pk_fma_f32 v[208:209], v[28:29], v[246:247], v[208:209] op_sel:[0,1,0] op_sel_hi:[1,1,1]
  v_pk_fma_f32 v[210:211], v[30:31], v[246:247], v[210:211] op_sel:[0,1,0] op_sel_hi:[1,1,1]
  v_pk_fma_f32 v[212:213], v[32:33], v[246:247], v[212:213] op_sel:[0,1,0] op_sel_hi:[1,1,1]
  v_pk_fma_f32 v[214:215], v[34:35], v[246:247], v[214:215] op_sel:[0,1,0] op_sel_hi:[1,1,1]
  v_pk_fma_f32 v[216:217], v[28:29], v[254:255], v[216:217] op_sel:[0,1,0] op_sel_hi:[1,1,1]
  v_pk_fma_f32 v[218:219], v[30:31], v[254:255], v[218:219] op_sel:[0,1,0] op_sel_hi:[1,1,1]
  v_pk_fma_f32 v[220:221], v[32:33], v[254:255], v[220:221] op_sel:[0,1,0] op_sel_hi:[1,1,1]
  v_pk_fma_f32 v[222:223], v[34:35], v[254:255], v[222:223] op_sel:[0,1,0] op_sel_hi:[1,1,1]
  v_permlane32_swap_b32 v160, v192
  v_permlane32_swap_b32 v161, v193
  v_permlane32_swap_b32 v162, v194
  v_permlane32_swap_b32 v163, v195
  v_permlane32_swap_b32 v164, v196
  v_permlane32_swap_b32 v165, v197
  v_permlane32_swap_b32 v166, v198
  v_permlane32_swap_b32 v167, v199
  v_permlane32_swap_b32 v168, v200
  v_permlane32_swap_b32 v169, v201
  v_permlane32_swap_b32 v170, v202
  v_permlane32_swap_b32 v171, v203
  v_permlane32_swap_b32 v172, v204
  v_permlane32_swap_b32 v173, v205
  v_permlane32_swap_b32 v174, v206
  v_permlane32_swap_b32 v175, v207
  v_permlane32_swap_b32 v176, v208
  v_permlane32_swap_b32 v177, v209
  v_permlane32_swap_b32 v178, v210
  v_permlane32_swap_b32 v179, v211
  v_permlane32_swap_b32 v180, v212
  v_permlane32_swap_b32 v181, v213
  v_permlane32_swap_b32 v182, v214
  v_permlane32_swap_b32 v183, v215
  v_permlane32_swap_b32 v184, v216
  v_permlane32_swap_b32 v185, v217
  v_permlane32_swap_b32 v186, v218
  v_permlane32_swap_b32 v187, v219
  v_permlane32_swap_b32 v188, v220
  v_permlane32_swap_b32 v189, v221
  v_permlane32_swap_b32 v190, v222
  v_permlane32_swap_b32 v191, v223
  v_add_f32 v160, v160, v192
  v_add_f32 v161, v161, v193
  v_add_f32 v162, v162, v194
  v_add_f32 v163, v163, v195
  v_add_f32 v164, v164, v196
  v_add_f32 v165, v165, v197
  v_add_f32 v166, v166, v198
  v_add_f32 v167, v167, v199
  v_add_f32 v168, v168, v200
  v_add_f32 v169, v169, v201
  v_add_f32 v170, v170, v202
  v_add_f32 v171, v171, v203
  v_add_f32 v172, v172, v204
  v_add_f32 v173, v173, v205
  v_add_f32 v174, v174, v206
  v_add_f32 v175, v175, v207
  v_add_f32 v176, v176, v208
  v_add_f32 v177, v177, v209
  v_add_f32 v178, v178, v210
  v_add_f32 v179, v179, v211
  v_add_f32 v180, v180, v212
  v_add_f32 v181, v181, v213
  v_add_f32 v182, v182, v214
  v_add_f32 v183, v183, v215
  v_add_f32 v184, v184, v216
  v_add_f32 v185, v185, v217
  v_add_f32 v186, v186, v218
  v_add_f32 v187, v187, v219
  v_add_f32 v188, v188, v220
  v_add_f32 v189, v189, v221
  v_add_f32 v190, v190, v222
  v_add_f32 v191, v191, v223
  v_permlane16_swap_b32 v160, v176
  v_permlane16_swap_b32 v161, v177
  v_permlane16_swap_b32 v162, v178
  v_permlane16_swap_b32 v163, v179
  v_permlane16_swap_b32 v164, v180
  v_permlane16_swap_b32 v165, v181
  v_permlane16_swap_b32 v166, v182
  v_permlane16_swap_b32 v167, v183
  v_permlane16_swap_b32 v168, v184
  v_permlane16_swap_b32 v169, v185
  v_permlane16_swap_b32 v170, v186
  v_permlane16_swap_b32 v171, v187
  v_permlane16_swap_b32 v172, v188
  v_permlane16_swap_b32 v173, v189
  v_permlane16_swap_b32 v174, v190
  v_permlane16_swap_b32 v175, v191
  v_add_f32 v160, v160, v176
  v_add_f32 v161, v161, v177
  v_add_f32 v162, v162, v178
  v_add_f32 v163, v163, v179
  v_add_f32 v164, v164, v180
  v_add_f32 v165, v165, v181
  v_add_f32 v166, v166, v182
  v_add_f32 v167, v167, v183
  v_add_f32 v168, v168, v184
  v_add_f32 v169, v169, v185
  v_add_f32 v170, v170, v186
  v_add_f32 v171, v171, v187
  v_add_f32 v172, v172, v188
  v_add_f32 v173, v173, v189
  v_add_f32 v174, v174, v190
  v_add_f32 v175, v175, v191
  v_add_f32_dpp v160, v160, v160 row_ror:8 row_mask:0xf bank_mask:0x3
  s_nop 1
  v_add_f32_dpp v160, v168, v168 row_ror:8 row_mask:0xf bank_mask:0xc
  v_add_f32_dpp v161, v161, v161 row_ror:8 row_mask:0xf bank_mask:0x3
  s_nop 1
  v_add_f32_dpp v161, v169, v169 row_ror:8 row_mask:0xf bank_mask:0xc
  v_add_f32_dpp v162, v162, v162 row_ror:8 row_mask:0xf bank_mask:0x3
  s_nop 1
  v_add_f32_dpp v162, v170, v170 row_ror:8 row_mask:0xf bank_mask:0xc
  v_add_f32_dpp v163, v163, v163 row_ror:8 row_mask:0xf bank_mask:0x3
  s_nop 1
  v_add_f32_dpp v163, v171, v171 row_ror:8 row_mask:0xf bank_mask:0xc
  v_add_f32_dpp v164, v164, v164 row_ror:8 row_mask:0xf bank_mask:0x3
  s_nop 1
  v_add_f32_dpp v164, v172, v172 row_ror:8 row_mask:0xf bank_mask:0xc
  v_add_f32_dpp v165, v165, v165 row_ror:8 row_mask:0xf bank_mask:0x3
  s_nop 1
  v_add_f32_dpp v165, v173, v173 row_ror:8 row_mask:0xf bank_mask:0xc
  v_add_f32_dpp v166, v166, v166 row_ror:8 row_mask:0xf bank_mask:0x3
  s_nop 1
  v_add_f32_dpp v166, v174, v174 row_ror:8 row_mask:0xf bank_mask:0xc
  v_add_f32_dpp v167, v167, v167 row_ror:8 row_mask:0xf bank_mask:0x3
  s_nop 1
  v_add_f32_dpp v167, v175, v175 row_ror:8 row_mask:0xf bank_mask:0xc
  v_add_f32_dpp v160, v160, v160 row_shl:4 row_mask:0xf bank_mask:0x5
  s_nop 1
  v_add_f32_dpp v160, v164, v164 row_shr:4 row_mask:0xf bank_mask:0xa
  v_add_f32_dpp v161, v161, v161 row_shl:4 row_mask:0xf bank_mask:0x5
  s_nop 1
  v_add_f32_dpp v161, v165, v165 row_shr:4 row_mask:0xf bank_mask:0xa
  v_add_f32_dpp v162, v162, v162 row_shl:4 row_mask:0xf bank_mask:0x5
  s_nop 1
  v_add_f32_dpp v162, v166, v166 row_shr:4 row_mask:0xf bank_mask:0xa
  v_add_f32_dpp v163, v163, v163 row_shl:4 row_mask:0xf bank_mask:0x5
  s_nop 1
  v_add_f32_dpp v163, v167, v167 row_shr:4 row_mask:0xf bank_mask:0xa
  v_bfe_u32 v61, v1, 3, 2
  v_lshlrev_b32 v61, 8, v61
  v_and_b32 v62, 32, v1
  v_lshl_add_u32 v61, v62, 2, v61
  v_and_b32 v62, 3, v1
  v_lshl_add_u32 v61, v62, 5, v61
  v_and_b32 v62, 4, v1
  v_lshl_add_u32 v61, v62, 2, v61
  s_lshl_b32 s27, s72, 10
  v_add_u32 v61, s27, v61
  ds_write_b128 v61, v[160:163] offset:12288
  s_lshl_b32 s27, s72, 2
  v_mov_b32 v61, s27
  v_mov_b32 v62, 1
  ds_write_b32 v61, v62 offset:16
  v_mov_b32 v61, 16
L1_fpoll:
  s_nop 4
  ds_read_b128 v[28:31], v61
  s_waitcnt lgkmcnt(0)
  v_and_b32 v28, v28, v29
  v_and_b32 v30, v30, v31
  v_and_b32 v28, v28, v30
  s_nop 0
  v_readfirstlane_b32 s27, v28
  s_nop 0
  s_cmp_eq_u32 s27, 1
  s_cbranch_scc1 L1_fpoll_ok
  s_sleep 1
  s_branch L1_fpoll
L1_fpoll_ok:
  s_nop 4
  v_and_b32 v61, 7, v1
  v_lshlrev_b32 v61, 4, v61
  v_lshrrev_b32 v62, 4, v1
  v_lshl_add_u32 v61, v62, 2, v61
  ds_read_b32 v28, v61 offset:12288
  ds_read_b32 v32, v61 offset:12416
  ds_read_b32 v29, v61 offset:13312
  ds_read_b32 v33, v61 offset:13440
  ds_read_b32 v30, v61 offset:14336
  ds_read_b32 v34, v61 offset:14464
  ds_read_b32 v31, v61 offset:15360
  ds_read_b32 v35, v61 offset:15488
  s_waitcnt lgkmcnt(0)
  v_add_f32 v28, v28, v29
  v_add_f32 v30, v30, v31
  v_add_f32 v32, v32, v33
  v_add_f32 v34, v34, v35
  v_add_f32 v28, v28, v30
  v_add_f32 v32, v32, v34
  v_cvt_pk_bf16_f32 v28, v28, v28
  v_lshlrev_b32 v28, 16, v28
  v_cvt_pk_bf16_f32 v32, v32, v32
  v_lshlrev_b32 v32, 16, v32
  v_mul_f32 v29, s80, v28
  v_exp_f32 v29, -v29
  s_nop 0
  v_add_f32 v29, 1.0, v29
  v_rcp_f32 v30, v29
  s_nop 0
  v_mul_f32 v31, v28, v30
  v_fma_f32 v33, -v31, v29, v28
  v_fma_f32 v31, v33, v30, v31
  v_cmp_eq_f32 vcc, 0, v30
  v_mul_f32 v33, v28, v30
  s_nop 0
  v_cndmask_b32 v31, v31, v33, vcc
  v_cvt_pk_bf16_f32 v31, v31, v31
  v_lshlrev_b32 v31, 16, v31
  v_mul_f32 v31, v31, v32
  v_cvt_pk_bf16_f32 v224, v31, v31
  v_lshlrev_b32 v224, 16, v224
  ds_read_b32 v28, v61 offset:12544
  ds_read_b32 v32, v61 offset:12672
  ds_read_b32 v29, v61 offset:13568
  ds_read_b32 v33, v61 offset:13696
  ds_read_b32 v30, v61 offset:14592
  ds_read_b32 v34, v61 offset:14720
  ds_read_b32 v31, v61 offset:15616
  ds_read_b32 v35, v61 offset:15744
  s_waitcnt lgkmcnt(0)
  v_add_f32 v28, v28, v29
  v_add_f32 v30, v30, v31
  v_add_f32 v32, v32, v33
  v_add_f32 v34, v34, v35
  v_add_f32 v28, v28, v30
  v_add_f32 v32, v32, v34
  v_cvt_pk_bf16_f32 v28, v28, v28
  v_lshlrev_b32 v28, 16, v28
  v_cvt_pk_bf16_f32 v32, v32, v32
  v_lshlrev_b32 v32, 16, v32
  v_mul_f32 v29, s80, v28
  v_exp_f32 v29, -v29
  s_nop 0
  v_add_f32 v29, 1.0, v29
  v_rcp_f32 v30, v29
  s_nop 0
  v_mul_f32 v31, v28, v30
  v_fma_f32 v33, -v31, v29, v28
  v_fma_f32 v31, v33, v30, v31
  v_cmp_eq_f32 vcc, 0, v30
  v_mul_f32 v33, v28, v30
  s_nop 0
  v_cndmask_b32 v31, v31, v33, vcc
  v_cvt_pk_bf16_f32 v31, v31, v31
  v_lshlrev_b32 v31, 16, v31
  v_mul_f32 v31, v31, v32
  v_cvt_pk_bf16_f32 v225, v31, v31
  v_lshlrev_b32 v225, 16, v225
  ds_read_b32 v28, v61 offset:12800
  ds_read_b32 v32, v61 offset:12928
  ds_read_b32 v29, v61 offset:13824
  ds_read_b32 v33, v61 offset:13952
  ds_read_b32 v30, v61 offset:14848
  ds_read_b32 v34, v61 offset:14976
  ds_read_b32 v31, v61 offset:15872
  ds_read_b32 v35, v61 offset:16000
  s_waitcnt lgkmcnt(0)
  v_add_f32 v28, v28, v29
  v_add_f32 v30, v30, v31
  v_add_f32 v32, v32, v33
  v_add_f32 v34, v34, v35
  v_add_f32 v28, v28, v30
  v_add_f32 v32, v32, v34
  v_cvt_pk_bf16_f32 v28, v28, v28
  v_lshlrev_b32 v28, 16, v28
  v_cvt_pk_bf16_f32 v32, v32, v32
  v_lshlrev_b32 v32, 16, v32
  v_mul_f32 v29, s80, v28
  v_exp_f32 v29, -v29
  s_nop 0
  v_add_f32 v29, 1.0, v29
  v_rcp_f32 v30, v29
  s_nop 0
  v_mul_f32 v31, v28, v30
  v_fma_f32 v33, -v31, v29, v28
  v_fma_f32 v31, v33, v30, v31
  v_cmp_eq_f32 vcc, 0, v30
  v_mul_f32 v33, v28, v30
  s_nop 0
  v_cndmask_b32 v31, v31, v33, vcc
  v_cvt_pk_bf16_f32 v31, v31, v31
  v_lshlrev_b32 v31, 16, v31
  v_mul_f32 v31, v31, v32
  v_cvt_pk_bf16_f32 v226, v31, v31
  v_lshlrev_b32 v226, 16, v226
  ds_read_b32 v28, v61 offset:13056
  ds_read_b32 v32, v61 offset:13184
  ds_read_b32 v29, v61 offset:14080
  ds_read_b32 v33, v61 offset:14208
  ds_read_b32 v30, v61 offset:15104
  ds_read_b32 v34, v61 offset:15232
  ds_read_b32 v31, v61 offset:16128
  ds_read_b32 v35, v61 offset:16256
  s_waitcnt lgkmcnt(0)
  v_add_f32 v28, v28, v29
  v_add_f32 v30, v30, v31
  v_add_f32 v32, v32, v33
  v_add_f32 v34, v34, v35
  v_add_f32 v28, v28, v30
  v_add_f32 v32, v32, v34
  v_cvt_pk_bf16_f32 v28, v28, v28
  v_lshlrev_b32 v28, 16, v28
  v_cvt_pk_bf16_f32 v32, v32, v32
  v_lshlrev_b32 v32, 16, v32
  v_mul_f32 v29, s80, v28
  v_exp_f32 v29, -v29
  s_nop 0
  v_add_f32 v29, 1.0, v29
  v_rcp_f32 v30, v29
  s_nop 0
  v_mul_f32 v31, v28, v30
  v_fma_f32 v33, -v31, v29, v28
  v_fma_f32 v31, v33, v30, v31
  v_cmp_eq_f32 vcc, 0, v30
  v_mul_f32 v33, v28, v30
  s_nop 0
  v_cndmask_b32 v31, v31, v33, vcc
  v_cvt_pk_bf16_f32 v31, v31, v31
  v_lshlrev_b32 v31, 16, v31
  v_mul_f32 v31, v31, v32
  v_cvt_pk_bf16_f32 v227, v31, v31
  v_lshlrev_b32 v227, 16, v227
  v_mov_b32 v160, 0
  v_mov_b32 v161, 0
  v_mov_b32 v162, 0
  v_mov_b32 v163, 0
  v_mov_b32 v164, 0
  v_mov_b32 v165, 0
  v_mov_b32 v166, 0
  v_mov_b32 v167, 0
  v_mov_b32 v168, 0
  v_mov_b32 v169, 0
  v_mov_b32 v170, 0
  v_mov_b32 v171, 0
  v_mov_b32 v172, 0
  v_mov_b32 v173, 0
  v_mov_b32 v174, 0
  v_mov_b32 v175, 0
  v_mov_b32 v176, 0
  v_mov_b32 v177, 0
  v_mov_b32 v178, 0
  v_mov_b32 v179, 0
  v_mov_b32 v180, 0
  v_mov_b32 v181, 0
  v_mov_b32 v182, 0
  v_mov_b32 v183, 0
  v_mov_b32 v184, 0
  v_mov_b32 v185, 0
  v_mov_b32 v186, 0
  v_mov_b32 v187, 0
  v_mov_b32 v188, 0
  v_mov_b32 v189, 0
  v_mov_b32 v190, 0
  v_mov_b32 v191, 0
  s_waitcnt vmcnt(7)
  v_lshlrev_b32 v28, 16, v128
  v_and_b32 v29, s31, v128
  v_lshlrev_b32 v30, 16, v129
  v_and_b32 v31, s31, v129
  v_lshlrev_b32 v32, 16, v130
  v_and_b32 v33, s31, v130
  v_lshlrev_b32 v34, 16, v131
  v_and_b32 v35, s31, v131
  v_mov_b32_dpp v12, v224 row_newbcast:0 row_mask:0xf bank_mask:0xf
  v_pk_fma_f32 v[160:161], v[28:29], v[12:13], v[160:161] op_sel_hi:[1,0,1]
  v_pk_fma_f32 v[162:163], v[30:31], v[12:13], v[162:163] op_sel_hi:[1,0,1]
  v_pk_fma_f32 v[164:165], v[32:33], v[12:13], v[164:165] op_sel_hi:[1,0,1]
  v_pk_fma_f32 v[166:167], v[34:35], v[12:13], v[166:167] op_sel_hi:[1,0,1]
  v_mov_b32_dpp v12, v225 row_newbcast:0 row_mask:0xf bank_mask:0xf
  v_pk_fma_f32 v[168:169], v[28:29], v[12:13], v[168:169] op_sel_hi:[1,0,1]
  v_pk_fma_f32 v[170:171], v[30:31], v[12:13], v[170:171] op_sel_hi:[1,0,1]
  v_pk_fma_f32 v[172:173], v[32:33], v[12:13], v[172:173] op_sel_hi:[1,0,1]
  v_pk_fma_f32 v[174:175], v[34:35], v[12:13], v[174:175] op_sel_hi:[1,0,1]
  v_mov_b32_dpp v12, v226 row_newbcast:0 row_mask:0xf bank_mask:0xf
  v_pk_fma_f32 v[176:177], v[28:29], v[12:13], v[176:177] op_sel_hi:[1,0,1]
  v_pk_fma_f32 v[178:179], v[30:31], v[12:13], v[178:179] op_sel_hi:[1,0,1]
  v_pk_fma_f32 v[180:181], v[32:33], v[12:13], v[180:181] op_sel_hi:[1,0,1]
  v_pk_fma_f32 v[182:183], v[34:35], v[12:13], v[182:183] op_sel_hi:[1,0,1]
  v_mov_b32_dpp v12, v227 row_newbcast:0 row_mask:0xf bank_mask:0xf
  v_pk_fma_f32 v[184:185], v[28:29], v[12:13], v[184:185] op_sel_hi:[1,0,1]
  v_pk_fma_f32 v[186:187], v[30:31], v[12:13], v[186:187] op_sel_hi:[1,0,1]
  v_pk_fma_f32 v[188:189], v[32:33], v[12:13], v[188:189] op_sel_hi:[1,0,1]
  v_pk_fma_f32 v[190:191], v[34:35], v[12:13], v[190:191] op_sel_hi:[1,0,1]
  s_waitcnt vmcnt(6)
  v_lshlrev_b32 v28, 16, v132
  v_and_b32 v29, s31, v132
  v_lshlrev_b32 v30, 16, v133
  v_and_b32 v31, s31, v133
  v_lshlrev_b32 v32, 16, v134
  v_and_b32 v33, s31, v134
  v_lshlrev_b32 v34, 16, v135
  v_and_b32 v35, s31, v135
  v_mov_b32_dpp v12, v224 row_newbcast:1 row_mask:0xf bank_mask:0xf
  v_pk_fma_f32 v[160:161], v[28:29], v[12:13], v[160:161] op_sel_hi:[1,0,1]
  v_pk_fma_f32 v[162:163], v[30:31], v[12:13], v[162:163] op_sel_hi:[1,0,1]
  v_pk_fma_f32 v[164:165], v[32:33], v[12:13], v[164:165] op_sel_hi:[1,0,1]
  v_pk_fma_f32 v[166:167], v[34:35], v[12:13], v[166:167] op_sel_hi:[1,0,1]
  v_mov_b32_dpp v12, v225 row_newbcast:1 row_mask:0xf bank_mask:0xf
  v_pk_fma_f32 v[168:169], v[28:29], v[12:13], v[168:169] op_sel_hi:[1,0,1]
  v_pk_fma_f32 v[170:171], v[30:31], v[12:13], v[170:171] op_sel_hi:[1,0,1]
  v_pk_fma_f32 v[172:173], v[32:33], v[12:13], v[172:173] op_sel_hi:[1,0,1]
  v_pk_fma_f32 v[174:175], v[34:35], v[12:13], v[174:175] op_sel_hi:[1,0,1]
  v_mov_b32_dpp v12, v226 row_newbcast:1 row_mask:0xf bank_mask:0xf
  v_pk_fma_f32 v[176:177], v[28:29], v[12:13], v[176:177] op_sel_hi:[1,0,1]
  v_pk_fma_f32 v[178:179], v[30:31], v[12:13], v[178:179] op_sel_hi:[1,0,1]
  v_pk_fma_f32 v[180:181], v[32:33], v[12:13], v[180:181] op_sel_hi:[1,0,1]
  v_pk_fma_f32 v[182:183], v[34:35], v[12:13], v[182:183] op_sel_hi:[1,0,1]
  v_mov_b32_dpp v12, v227 row_newbcast:1 row_mask:0xf bank_mask:0xf
  v_pk_fma_f32 v[184:185], v[28:29], v[12:13], v[184:185] op_sel_hi:[1,0,1]
  v_pk_fma_f32 v[186:187], v[30:31], v[12:13], v[186:187] op_sel_hi:[1,0,1]
  v_pk_fma_f32 v[188:189], v[32:33], v[12:13], v[188:189] op_sel_hi:[1,0,1]
  v_pk_fma_f32 v[190:191], v[34:35], v[12:13], v[190:191] op_sel_hi:[1,0,1]
  s_waitcnt vmcnt(5)
  v_lshlrev_b32 v28, 16, v136
  v_and_b32 v29, s31, v136
  v_lshlrev_b32 v30, 16, v137
  v_and_b32 v31, s31, v137
  v_lshlrev_b32 v32, 16, v138
  v_and_b32 v33, s31, v138
  v_lshlrev_b32 v34, 16, v139
  v_and_b32 v35, s31, v139
  v_mov_b32_dpp v12, v224 row_newbcast:2 row_mask:0xf bank_mask:0xf
  v_pk_fma_f32 v[160:161], v[28:29], v[12:13], v[160:161] op_sel_hi:[1,0,1]
  v_pk_fma_f32 v[162:163], v[30:31], v[12:13], v[162:163] op_sel_hi:[1,0,1]
  v_pk_fma_f32 v[164:165], v[32:33], v[12:13], v[164:165] op_sel_hi:[1,0,1]
  v_pk_fma_f32 v[166:167], v[34:35], v[12:13], v[166:167] op_sel_hi:[1,0,1]
  v_mov_b32_dpp v12, v225 row_newbcast:2 row_mask:0xf bank_mask:0xf
  v_pk_fma_f32 v[168:169], v[28:29], v[12:13], v[168:169] op_sel_hi:[1,0,1]
  v_pk_fma_f32 v[170:171], v[30:31], v[12:13], v[170:171] op_sel_hi:[1,0,1]
  v_pk_fma_f32 v[172:173], v[32:33], v[12:13], v[172:173] op_sel_hi:[1,0,1]
  v_pk_fma_f32 v[174:175], v[34:35], v[12:13], v[174:175] op_sel_hi:[1,0,1]
  v_mov_b32_dpp v12, v226 row_newbcast:2 row_mask:0xf bank_mask:0xf
  v_pk_fma_f32 v[176:177], v[28:29], v[12:13], v[176:177] op_sel_hi:[1,0,1]
  v_pk_fma_f32 v[178:179], v[30:31], v[12:13], v[178:179] op_sel_hi:[1,0,1]
  v_pk_fma_f32 v[180:181], v[32:33], v[12:13], v[180:181] op_sel_hi:[1,0,1]
  v_pk_fma_f32 v[182:183], v[34:35], v[12:13], v[182:183] op_sel_hi:[1,0,1]
  v_mov_b32_dpp v12, v227 row_newbcast:2 row_mask:0xf bank_mask:0xf
  v_pk_fma_f32 v[184:185], v[28:29], v[12:13], v[184:185] op_sel_hi:[1,0,1]
  v_pk_fma_f32 v[186:187], v[30:31], v[12:13], v[186:187] op_sel_hi:[1,0,1]
  v_pk_fma_f32 v[188:189], v[32:33], v[12:13], v[188:189] op_sel_hi:[1,0,1]
  v_pk_fma_f32 v[190:191], v[34:35], v[12:13], v[190:191] op_sel_hi:[1,0,1]
  s_waitcnt vmcnt(4)
  v_lshlrev_b32 v28, 16, v140
  v_and_b32 v29, s31, v140
  v_lshlrev_b32 v30, 16, v141
  v_and_b32 v31, s31, v141
  v_lshlrev_b32 v32, 16, v142
  v_and_b32 v33, s31, v142
  v_lshlrev_b32 v34, 16, v143
  v_and_b32 v35, s31, v143
  v_mov_b32_dpp v12, v224 row_newbcast:3 row_mask:0xf bank_mask:0xf
  v_pk_fma_f32 v[160:161], v[28:29], v[12:13], v[160:161] op_sel_hi:[1,0,1]
  v_pk_fma_f32 v[162:163], v[30:31], v[12:13], v[162:163] op_sel_hi:[1,0,1]
  v_pk_fma_f32 v[164:165], v[32:33], v[12:13], v[164:165] op_sel_hi:[1,0,1]
  v_pk_fma_f32 v[166:167], v[34:35], v[12:13], v[166:167] op_sel_hi:[1,0,1]
  v_mov_b32_dpp v12, v225 row_newbcast:3 row_mask:0xf bank_mask:0xf
  v_pk_fma_f32 v[168:169], v[28:29], v[12:13], v[168:169] op_sel_hi:[1,0,1]
  v_pk_fma_f32 v[170:171], v[30:31], v[12:13], v[170:171] op_sel_hi:[1,0,1]
  v_pk_fma_f32 v[172:173], v[32:33], v[12:13], v[172:173] op_sel_hi:[1,0,1]
  v_pk_fma_f32 v[174:175], v[34:35], v[12:13], v[174:175] op_sel_hi:[1,0,1]
  v_mov_b32_dpp v12, v226 row_newbcast:3 row_mask:0xf bank_mask:0xf
  v_pk_fma_f32 v[176:177], v[28:29], v[12:13], v[176:177] op_sel_hi:[1,0,1]
  v_pk_fma_f32 v[178:179], v[30:31], v[12:13], v[178:179] op_sel_hi:[1,0,1]
  v_pk_fma_f32 v[180:181], v[32:33], v[12:13], v[180:181] op_sel_hi:[1,0,1]
  v_pk_fma_f32 v[182:183], v[34:35], v[12:13], v[182:183] op_sel_hi:[1,0,1]
  v_mov_b32_dpp v12, v227 row_newbcast:3 row_mask:0xf bank_mask:0xf
  v_pk_fma_f32 v[184:185], v[28:29], v[12:13], v[184:185] op_sel_hi:[1,0,1]
  v_pk_fma_f32 v[186:187], v[30:31], v[12:13], v[186:187] op_sel_hi:[1,0,1]
  v_pk_fma_f32 v[188:189], v[32:33], v[12:13], v[188:189] op_sel_hi:[1,0,1]
  v_pk_fma_f32 v[190:191], v[34:35], v[12:13], v[190:191] op_sel_hi:[1,0,1]
  s_waitcnt vmcnt(3)
  v_lshlrev_b32 v28, 16, v144
  v_and_b32 v29, s31, v144
  v_lshlrev_b32 v30, 16, v145
  v_and_b32 v31, s31, v145
  v_lshlrev_b32 v32, 16, v146
  v_and_b32 v33, s31, v146
  v_lshlrev_b32 v34, 16, v147
  v_and_b32 v35, s31, v147
  v_mov_b32_dpp v12, v224 row_newbcast:4 row_mask:0xf bank_mask:0xf
  v_pk_fma_f32 v[160:161], v[28:29], v[12:13], v[160:161] op_sel_hi:[1,0,1]
  v_pk_fma_f32 v[162:163], v[30:31], v[12:13], v[162:163] op_sel_hi:[1,0,1]
  v_pk_fma_f32 v[164:165], v[32:33], v[12:13], v[164:165] op_sel_hi:[1,0,1]
  v_pk_fma_f32 v[166:167], v[34:35], v[12:13], v[166:167] op_sel_hi:[1,0,1]
  v_mov_b32_dpp v12, v225 row_newbcast:4 row_mask:0xf bank_mask:0xf
  v_pk_fma_f32 v[168:169], v[28:29], v[12:13], v[168:169] op_sel_hi:[1,0,1]
  v_pk_fma_f32 v[170:171], v[30:31], v[12:13], v[170:171] op_sel_hi:[1,0,1]
  v_pk_fma_f32 v[172:173], v[32:33], v[12:13], v[172:173] op_sel_hi:[1,0,1]
  v_pk_fma_f32 v[174:175], v[34:35], v[12:13], v[174:175] op_sel_hi:[1,0,1]
  v_mov_b32_dpp v12, v226 row_newbcast:4 row_mask:0xf bank_mask:0xf
  v_pk_fma_f32 v[176:177], v[28:29], v[12:13], v[176:177] op_sel_hi:[1,0,1]
  v_pk_fma_f32 v[178:179], v[30:31], v[12:13], v[178:179] op_sel_hi:[1,0,1]
  v_pk_fma_f32 v[180:181], v[32:33], v[12:13], v[180:181] op_sel_hi:[1,0,1]
  v_pk_fma_f32 v[182:183], v[34:35], v[12:13], v[182:183] op_sel_hi:[1,0,1]
  v_mov_b32_dpp v12, v227 row_newbcast:4 row_mask:0xf bank_mask:0xf
  v_pk_fma_f32 v[184:185], v[28:29], v[12:13], v[184:185] op_sel_hi:[1,0,1]
  v_pk_fma_f32 v[186:187], v[30:31], v[12:13], v[186:187] op_sel_hi:[1,0,1]
  v_pk_fma_f32 v[188:189], v[32:33], v[12:13], v[188:189] op_sel_hi:[1,0,1]
  v_pk_fma_f32 v[190:191], v[34:35], v[12:13], v[190:191] op_sel_hi:[1,0,1]
  s_waitcnt vmcnt(2)
  v_lshlrev_b32 v28, 16, v148
  v_and_b32 v29, s31, v148
  v_lshlrev_b32 v30, 16, v149
  v_and_b32 v31, s31, v149
  v_lshlrev_b32 v32, 16, v150
  v_and_b32 v33, s31, v150
  v_lshlrev_b32 v34, 16, v151
  v_and_b32 v35, s31, v151
  v_mov_b32_dpp v12, v224 row_newbcast:5 row_mask:0xf bank_mask:0xf
  v_pk_fma_f32 v[160:161], v[28:29], v[12:13], v[160:161] op_sel_hi:[1,0,1]
  v_pk_fma_f32 v[162:163], v[30:31], v[12:13], v[162:163] op_sel_hi:[1,0,1]
  v_pk_fma_f32 v[164:165], v[32:33], v[12:13], v[164:165] op_sel_hi:[1,0,1]
  v_pk_fma_f32 v[166:167], v[34:35], v[12:13], v[166:167] op_sel_hi:[1,0,1]
  v_mov_b32_dpp v12, v225 row_newbcast:5 row_mask:0xf bank_mask:0xf
  v_pk_fma_f32 v[168:169], v[28:29], v[12:13], v[168:169] op_sel_hi:[1,0,1]
  v_pk_fma_f32 v[170:171], v[30:31], v[12:13], v[170:171] op_sel_hi:[1,0,1]
  v_pk_fma_f32 v[172:173], v[32:33], v[12:13], v[172:173] op_sel_hi:[1,0,1]
  v_pk_fma_f32 v[174:175], v[34:35], v[12:13], v[174:175] op_sel_hi:[1,0,1]
  v_mov_b32_dpp v12, v226 row_newbcast:5 row_mask:0xf bank_mask:0xf
  v_pk_fma_f32 v[176:177], v[28:29], v[12:13], v[176:177] op_sel_hi:[1,0,1]
  v_pk_fma_f32 v[178:179], v[30:31], v[12:13], v[178:179] op_sel_hi:[1,0,1]
  v_pk_fma_f32 v[180:181], v[32:33], v[12:13], v[180:181] op_sel_hi:[1,0,1]
  v_pk_fma_f32 v[182:183], v[34:35], v[12:13], v[182:183] op_sel_hi:[1,0,1]
  v_mov_b32_dpp v12, v227 row_newbcast:5 row_mask:0xf bank_mask:0xf
  v_pk_fma_f32 v[184:185], v[28:29], v[12:13], v[184:185] op_sel_hi:[1,0,1]
  v_pk_fma_f32 v[186:187], v[30:31], v[12:13], v[186:187] op_sel_hi:[1,0,1]
  v_pk_fma_f32 v[188:189], v[32:33], v[12:13], v[188:189] op_sel_hi:[1,0,1]
  v_pk_fma_f32 v[190:191], v[34:35], v[12:13], v[190:191] op_sel_hi:[1,0,1]
  s_waitcnt vmcnt(1)
  v_lshlrev_b32 v28, 16, v152
  v_and_b32 v29, s31, v152
  v_lshlrev_b32 v30, 16, v153
  v_and_b32 v31, s31, v153
  v_lshlrev_b32 v32, 16, v154
  v_and_b32 v33, s31, v154
  v_lshlrev_b32 v34, 16, v155
  v_and_b32 v35, s31, v155
  v_mov_b32_dpp v12, v224 row_newbcast:6 row_mask:0xf bank_mask:0xf
  v_pk_fma_f32 v[160:161], v[28:29], v[12:13], v[160:161] op_sel_hi:[1,0,1]
  v_pk_fma_f32 v[162:163], v[30:31], v[12:13], v[162:163] op_sel_hi:[1,0,1]
  v_pk_fma_f32 v[164:165], v[32:33], v[12:13], v[164:165] op_sel_hi:[1,0,1]
  v_pk_fma_f32 v[166:167], v[34:35], v[12:13], v[166:167] op_sel_hi:[1,0,1]
  v_mov_b32_dpp v12, v225 row_newbcast:6 row_mask:0xf bank_mask:0xf
  v_pk_fma_f32 v[168:169], v[28:29], v[12:13], v[168:169] op_sel_hi:[1,0,1]
  v_pk_fma_f32 v[170:171], v[30:31], v[12:13], v[170:171] op_sel_hi:[1,0,1]
  v_pk_fma_f32 v[172:173], v[32:33], v[12:13], v[172:173] op_sel_hi:[1,0,1]
  v_pk_fma_f32 v[174:175], v[34:35], v[12:13], v[174:175] op_sel_hi:[1,0,1]
  v_mov_b32_dpp v12, v226 row_newbcast:6 row_mask:0xf bank_mask:0xf
  v_pk_fma_f32 v[176:177], v[28:29], v[12:13], v[176:177] op_sel_hi:[1,0,1]
  v_pk_fma_f32 v[178:179], v[30:31], v[12:13], v[178:179] op_sel_hi:[1,0,1]
  v_pk_fma_f32 v[180:181], v[32:33], v[12:13], v[180:181] op_sel_hi:[1,0,1]
  v_pk_fma_f32 v[182:183], v[34:35], v[12:13], v[182:183] op_sel_hi:[1,0,1]
  v_mov_b32_dpp v12, v227 row_newbcast:6 row_mask:0xf bank_mask:0xf
  v_pk_fma_f32 v[184:185], v[28:29], v[12:13], v[184:185] op_sel_hi:[1,0,1]
  v_pk_fma_f32 v[186:187], v[30:31], v[12:13], v[186:187] op_sel_hi:[1,0,1]
  v_pk_fma_f32 v[188:189], v[32:33], v[12:13], v[188:189] op_sel_hi:[1,0,1]
  v_pk_fma_f32 v[190:191], v[34:35], v[12:13], v[190:191] op_sel_hi:[1,0,1]
  s_waitcnt vmcnt(0)
  v_lshlrev_b32 v28, 16, v156
  v_and_b32 v29, s31, v156
  v_lshlrev_b32 v30, 16, v157
  v_and_b32 v31, s31, v157
  v_lshlrev_b32 v32, 16, v158
  v_and_b32 v33, s31, v158
  v_lshlrev_b32 v34, 16, v159
  v_and_b32 v35, s31, v159
  v_mov_b32_dpp v12, v224 row_newbcast:7 row_mask:0xf bank_mask:0xf
  v_pk_fma_f32 v[160:161], v[28:29], v[12:13], v[160:161] op_sel_hi:[1,0,1]
  v_pk_fma_f32 v[162:163], v[30:31], v[12:13], v[162:163] op_sel_hi:[1,0,1]
  v_pk_fma_f32 v[164:165], v[32:33], v[12:13], v[164:165] op_sel_hi:[1,0,1]
  v_pk_fma_f32 v[166:167], v[34:35], v[12:13], v[166:167] op_sel_hi:[1,0,1]
  v_mov_b32_dpp v12, v225 row_newbcast:7 row_mask:0xf bank_mask:0xf
  v_pk_fma_f32 v[168:169], v[28:29], v[12:13], v[168:169] op_sel_hi:[1,0,1]
  v_pk_fma_f32 v[170:171], v[30:31], v[12:13], v[170:171] op_sel_hi:[1,0,1]
  v_pk_fma_f32 v[172:173], v[32:33], v[12:13], v[172:173] op_sel_hi:[1,0,1]
  v_pk_fma_f32 v[174:175], v[34:35], v[12:13], v[174:175] op_sel_hi:[1,0,1]
  v_mov_b32_dpp v12, v226 row_newbcast:7 row_mask:0xf bank_mask:0xf
  v_pk_fma_f32 v[176:177], v[28:29], v[12:13], v[176:177] op_sel_hi:[1,0,1]
  v_pk_fma_f32 v[178:179], v[30:31], v[12:13], v[178:179] op_sel_hi:[1,0,1]
  v_pk_fma_f32 v[180:181], v[32:33], v[12:13], v[180:181] op_sel_hi:[1,0,1]
  v_pk_fma_f32 v[182:183], v[34:35], v[12:13], v[182:183] op_sel_hi:[1,0,1]
  v_mov_b32_dpp v12, v227 row_newbcast:7 row_mask:0xf bank_mask:0xf
  v_pk_fma_f32 v[184:185], v[28:29], v[12:13], v[184:185] op_sel_hi:[1,0,1]
  v_pk_fma_f32 v[186:187], v[30:31], v[12:13], v[186:187] op_sel_hi:[1,0,1]
  v_pk_fma_f32 v[188:189], v[32:33], v[12:13], v[188:189] op_sel_hi:[1,0,1]
  v_pk_fma_f32 v[190:191], v[34:35], v[12:13], v[190:191] op_sel_hi:[1,0,1]
  v_permlane32_swap_b32 v160, v176
  v_permlane32_swap_b32 v161, v177
  v_permlane32_swap_b32 v162, v178
  v_permlane32_swap_b32 v163, v179
  v_permlane32_swap_b32 v164, v180
  v_permlane32_swap_b32 v165, v181
  v_permlane32_swap_b32 v166, v182
  v_permlane32_swap_b32 v167, v183
  v_permlane32_swap_b32 v168, v184
  v_permlane32_swap_b32 v169, v185
  v_permlane32_swap_b32 v170, v186
  v_permlane32_swap_b32 v171, v187
  v_permlane32_swap_b32 v172, v188
  v_permlane32_swap_b32 v173, v189
  v_permlane32_swap_b32 v174, v190
  v_permlane32_swap_b32 v175, v191
  v_add_f32 v160, v160, v176
  v_add_f32 v161, v161, v177
  v_add_f32 v162, v162, v178
  v_add_f32 v163, v163, v179
  v_add_f32 v164, v164, v180
  v_add_f32 v165, v165, v181
  v_add_f32 v166, v166, v182
  v_add_f32 v167, v167, v183
  v_add_f32 v168, v168, v184
  v_add_f32 v169, v169, v185
  v_add_f32 v170, v170, v186
  v_add_f32 v171, v171, v187
  v_add_f32 v172, v172, v188
  v_add_f32 v173, v173, v189
  v_add_f32 v174, v174, v190
  v_add_f32 v175, v175, v191
  v_permlane16_swap_b32 v160, v168
  v_permlane16_swap_b32 v161, v169
  v_permlane16_swap_b32 v162, v170
  v_permlane16_swap_b32 v163, v171
  v_permlane16_swap_b32 v164, v172
  v_permlane16_swap_b32 v165, v173
  v_permlane16_swap_b32 v166, v174
  v_permlane16_swap_b32 v167, v175
  v_add_f32 v36, v160, v168
  v_add_f32 v37, v161, v169
  v_add_f32 v38, v162, v170
  v_add_f32 v39, v163, v171
  v_add_f32 v40, v164, v172
  v_add_f32 v41, v165, v173
  v_add_f32 v42, v166, v174
  v_add_f32 v43, v167, v175
L1_noffn:
  s_nop 4
  s_mov_b32 s60, s44
  s_mov_b32 s61, s45
  s_mov_b32 s62, 4194304
  s_mov_b32 s63, 0x00020000
  s_lshl_b32 s27, s25, 17
  s_lshl_b32 s28, s72, 8
  s_add_u32 s27, s27, s28
  buffer_load_dwordx4 v[64:67], v3, s[60:63], s27 offen
  s_add_u32 s27, s27, 4096
  buffer_load_dwordx4 v[68:71], v3, s[60:63], s27 offen
  s_add_u32 s27, s27, 4096
  buffer_load_dwordx4 v[72:75], v3, s[60:63], s27 offen
  s_add_u32 s27, s27, 4096
  buffer_load_dwordx4 v[76:79], v3, s[60:63], s27 offen
  s_add_u32 s27, s27, 4096
  buffer_load_dwordx4 v[80:83], v3, s[60:63], s27 offen
  s_add_u32 s27, s27, 4096
  buffer_load_dwordx4 v[84:87], v3, s[60:63], s27 offen
  s_add_u32 s27, s27, 4096
  buffer_load_dwordx4 v[88:91], v3, s[60:63], s27 offen
  s_add_u32 s27, s27, 4096
  buffer_load_dwordx4 v[92:95], v3, s[60:63], s27 offen
  s_add_u32 s27, s27, 4096
  buffer_load_dwordx4 v[96:99], v3, s[60:63], s27 offen
  s_add_u32 s27, s27, 4096
  buffer_load_dwordx4 v[100:103], v3, s[60:63], s27 offen
  s_add_u32 s27, s27, 4096
  buffer_load_dwordx4 v[104:107], v3, s[60:63], s27 offen
  s_add_u32 s27, s27, 4096
  buffer_load_dwordx4 v[108:111], v3, s[60:63], s27 offen
  s_add_u32 s27, s27, 4096
  buffer_load_dwordx4 v[112:115], v3, s[60:63], s27 offen
  s_add_u32 s27, s27, 4096
  buffer_load_dwordx4 v[116:119], v3, s[60:63], s27 offen
  s_add_u32 s27, s27, 4096
  buffer_load_dwordx4 v[120:123], v3, s[60:63], s27 offen
  s_add_u32 s27, s27, 4096
  buffer_load_dwordx4 v[124:127], v3, s[60:63], s27 offen
  s_add_u32 s27, s27, 4096
  buffer_load_dwordx4 v[128:131], v3, s[60:63], s27 offen
  s_add_u32 s27, s27, 4096
  buffer_load_dwordx4 v[132:135], v3, s[60:63], s27 offen
  s_add_u32 s27, s27, 4096
  buffer_load_dwordx4 v[136:139], v3, s[60:63], s27 offen
  s_add_u32 s27, s27, 4096
  buffer_load_dwordx4 v[140:143], v3, s[60:63], s27 offen
  s_add_u32 s27, s27, 4096
  buffer_load_dwordx4 v[144:147], v3, s[60:63], s27 offen
  s_add_u32 s27, s27, 4096
  buffer_load_dwordx4 v[148:151], v3, s[60:63], s27 offen
  s_add_u32 s27, s27, 4096
  buffer_load_dwordx4 v[152:155], v3, s[60:63], s27 offen
  s_add_u32 s27, s27, 4096
  buffer_load_dwordx4 v[156:159], v3, s[60:63], s27 offen
  s_add_u32 s27, s27, 4096
  buffer_load_dwordx4 v[160:163], v3, s[60:63], s27 offen
  s_add_u32 s27, s27, 4096
  buffer_load_dwordx4 v[164:167], v3, s[60:63], s27 offen
  s_add_u32 s27, s27, 4096
  buffer_load_dwordx4 v[168:171], v3, s[60:63], s27 offen
  s_add_u32 s27, s27, 4096
  buffer_load_dwordx4 v[172:175], v3, s[60:63], s27 offen
  s_add_u32 s27, s27, 4096
  buffer_load_dwordx4 v[176:179], v3, s[60:63], s27 offen
  s_add_u32 s27, s27, 4096
  buffer_load_dwordx4 v[180:183], v3, s[60:63], s27 offen
  s_add_u32 s27, s27, 4096
  buffer_load_dwordx4 v[184:187], v3, s[60:63], s27 offen
  s_add_u32 s27, s27, 4096
  buffer_load_dwordx4 v[188:191], v3, s[60:63], s27 offen
  s_waitcnt vmcnt(0)
  s_mov_b32 s27, 0x05040100
  s_mov_b32 s28, 0x07060302
  v_perm_b32 v28, v68, v64, s27
  v_perm_b32 v68, v68, v64, s28
  v_mov_b32 v64, v28
  v_perm_b32 v29, v69, v65, s27
  v_perm_b32 v69, v69, v65, s28
  v_mov_b32 v65, v29
  v_perm_b32 v30, v70, v66, s27
  v_perm_b32 v70, v70, v66, s28
  v_mov_b32 v66, v30
  v_perm_b32 v31, v71, v67, s27
  v_perm_b32 v71, v71, v67, s28
  v_mov_b32 v67, v31
  v_perm_b32 v28, v76, v72, s27
  v_perm_b32 v76, v76, v72, s28
  v_mov_b32 v72, v28
  v_perm_b32 v29, v77, v73, s27
  v_perm_b32 v77, v77, v73, s28
  v_mov_b32 v73, v29
  v_perm_b32 v30, v78, v74, s27
  v_perm_b32 v78, v78, v74, s28
  v_mov_b32 v74, v30
  v_perm_b32 v31, v79, v75, s27
  v_perm_b32 v79, v79, v75, s28
  v_mov_b32 v75, v31
  v_perm_b32 v28, v84, v80, s27
  v_perm_b32 v84, v84, v80, s28
  v_mov_b32 v80, v28
  v_perm_b32 v29, v85, v81, s27
  v_perm_b32 v85, v85, v81, s28
  v_mov_b32 v81, v29
  v_perm_b32 v30, v86, v82, s27
  v_perm_b32 v86, v86, v82, s28
  v_mov_b32 v82, v30
  v_perm_b32 v31, v87, v83, s27
  v_perm_b32 v87, v87, v83, s28
  v_mov_b32 v83, v31
  v_perm_b32 v28, v92, v88, s27
  v_perm_b32 v92, v92, v88, s28
  v_mov_b32 v88, v28
  v_perm_b32 v29, v93, v89, s27
  v_perm_b32 v93, v93, v89, s28
  v_mov_b32 v89, v29
  v_perm_b32 v30, v94, v90, s27
  v_perm_b32 v94, v94, v90, s28
  v_mov_b32 v90, v30
  v_perm_b32 v31, v95, v91, s27
  v_perm_b32 v95, v95, v91, s28
  v_mov_b32 v91, v31
  v_perm_b32 v28, v100, v96, s27
  v_perm_b32 v100, v100, v96, s28
  v_mov_b32 v96, v28
  v_perm_b32 v29, v101, v97, s27
  v_perm_b32 v101, v101, v97, s28
  v_mov_b32 v97, v29
  v_perm_b32 v30, v102, v98, s27
  v_perm_b32 v102, v102, v98, s28
  v_mov_b32 v98, v30
  v_perm_b32 v31, v103, v99, s27
  v_perm_b32 v103, v103, v99, s28
  v_mov_b32 v99, v31
  v_perm_b32 v28, v108, v104, s27
  v_perm_b32 v108, v108, v104, s28
  v_mov_b32 v104, v28
  v_perm_b32 v29, v109, v105, s27
  v_perm_b32 v109, v109, v105, s28
  v_mov_b32 v105, v29
  v_perm_b32 v30, v110, v106, s27
  v_perm_b32 v110, v110, v106, s28
  v_mov_b32 v106, v30
  v_perm_b32 v31, v111, v107, s27
  v_perm_b32 v111, v111, v107, s28
  v_mov_b32 v107, v31
  v_perm_b32 v28, v116, v112, s27
  v_perm_b32 v116, v116, v112, s28
  v_mov_b32 v112, v28
  v_perm_b32 v29, v117, v113, s27
  v_perm_b32 v117, v117, v113, s28
  v_mov_b32 v113, v29
  v_perm_b32 v30, v118, v114, s27
  v_perm_b32 v118, v118, v114, s28
  v_mov_b32 v114, v30
  v_perm_b32 v31, v119, v115, s27
  v_perm_b32 v119, v119, v115, s28
  v_mov_b32 v115, v31
  v_perm_b32 v28, v124, v120, s27
  v_perm_b32 v124, v124, v120, s28
  v_mov_b32 v120, v28
  v_perm_b32 v29, v125, v121, s27
  v_perm_b32 v125, v125, v121, s28
  v_mov_b32 v121, v29
  v_perm_b32 v30, v126, v122, s27
  v_perm_b32 v126, v126, v122, s28
  v_mov_b32 v122, v30
  v_perm_b32 v31, v127, v123, s27
  v_perm_b32 v127, v127, v123, s28
  v_mov_b32 v123, v31
  v_perm_b32 v28, v132, v128, s27
  v_perm_b32 v132, v132, v128, s28
  v_mov_b32 v128, v28
  v_perm_b32 v29, v133, v129, s27
  v_perm_b32 v133, v133, v129, s28
  v_mov_b32 v129, v29
  v_perm_b32 v30, v134, v130, s27
  v_perm_b32 v134, v134, v130, s28
  v_mov_b32 v130, v30
  v_perm_b32 v31, v135, v131, s27
  v_perm_b32 v135, v135, v131, s28
  v_mov_b32 v131, v31
  v_perm_b32 v28, v140, v136, s27
  v_perm_b32 v140, v140, v136, s28
  v_mov_b32 v136, v28
  v_perm_b32 v29, v141, v137, s27
  v_perm_b32 v141, v141, v137, s28
  v_mov_b32 v137, v29
  v_perm_b32 v30, v142, v138, s27
  v_perm_b32 v142, v142, v138, s28
  v_mov_b32 v138, v30
  v_perm_b32 v31, v143, v139, s27
  v_perm_b32 v143, v143, v139, s28
  v_mov_b32 v139, v31
  v_perm_b32 v28, v148, v144, s27
  v_perm_b32 v148, v148, v144, s28
  v_mov_b32 v144, v28
  v_perm_b32 v29, v149, v145, s27
  v_perm_b32 v149, v149, v145, s28
  v_mov_b32 v145, v29
  v_perm_b32 v30, v150, v146, s27
  v_perm_b32 v150, v150, v146, s28
  v_mov_b32 v146, v30
  v_perm_b32 v31, v151, v147, s27
  v_perm_b32 v151, v151, v147, s28
  v_mov_b32 v147, v31
  v_perm_b32 v28, v156, v152, s27
  v_perm_b32 v156, v156, v152, s28
  v_mov_b32 v152, v28
  v_perm_b32 v29, v157, v153, s27
  v_perm_b32 v157, v157, v153, s28
  v_mov_b32 v153, v29
  v_perm_b32 v30, v158, v154, s27
  v_perm_b32 v158, v158, v154, s28
  v_mov_b32 v154, v30
  v_perm_b32 v31, v159, v155, s27
  v_perm_b32 v159, v159, v155, s28
  v_mov_b32 v155, v31
  v_perm_b32 v28, v164, v160, s27
  v_perm_b32 v164, v164, v160, s28
  v_mov_b32 v160, v28
  v_perm_b32 v29, v165, v161, s27
  v_perm_b32 v165, v165, v161, s28
  v_mov_b32 v161, v29
  v_perm_b32 v30, v166, v162, s27
  v_perm_b32 v166, v166, v162, s28
  v_mov_b32 v162, v30
  v_perm_b32 v31, v167, v163, s27
  v_perm_b32 v167, v167, v163, s28
  v_mov_b32 v163, v31
  v_perm_b32 v28, v172, v168, s27
  v_perm_b32 v172, v172, v168, s28
  v_mov_b32 v168, v28
  v_perm_b32 v29, v173, v169, s27
  v_perm_b32 v173, v173, v169, s28
  v_mov_b32 v169, v29
  v_perm_b32 v30, v174, v170, s27
  v_perm_b32 v174, v174, v170, s28
  v_mov_b32 v170, v30
  v_perm_b32 v31, v175, v171, s27
  v_perm_b32 v175, v175, v171, s28
  v_mov_b32 v171, v31
  v_perm_b32 v28, v180, v176, s27
  v_perm_b32 v180, v180, v176, s28
  v_mov_b32 v176, v28
  v_perm_b32 v29, v181, v177, s27
  v_perm_b32 v181, v181, v177, s28
  v_mov_b32 v177, v29
  v_perm_b32 v30, v182, v178, s27
  v_perm_b32 v182, v182, v178, s28
  v_mov_b32 v178, v30
  v_perm_b32 v31, v183, v179, s27
  v_perm_b32 v183, v183, v179, s28
  v_mov_b32 v179, v31
  v_perm_b32 v28, v188, v184, s27
  v_perm_b32 v188, v188, v184, s28
  v_mov_b32 v184, v28
  v_perm_b32 v29, v189, v185, s27
  v_perm_b32 v189, v189, v185, s28
  v_mov_b32 v185, v29
  v_perm_b32 v30, v190, v186, s27
  v_perm_b32 v190, v190, v186, s28
  v_mov_b32 v186, v30
  v_perm_b32 v31, v191, v187, s27
  v_perm_b32 v191, v191, v187, s28
  v_mov_b32 v187, v31
  v_and_b32 v61, 15, v1
  v_lshlrev_b32 v61, 5, v61
  v_lshrrev_b32 v62, 4, v1
  v_lshl_add_u32 v14, v62, 2, v61
L1_final:
  s_nop 4
  s_barrier
  s_cmp_eq_u32 s74, 0
  s_cbranch_scc1 L1_nozf
  v_lshrrev_b32 v61, 4, v1
  v_lshlrev_b32 v61, 17, v61
  v_and_b32 v62, 15, v1
  v_lshl_add_u32 v61, v62, 5, v61
  s_lshl_b32 s27, s26, 11
  s_lshl_b32 s28, s72, 9
  s_add_u32 s27, s27, s28
  s_add_u32 s27, s27, 524288
  buffer_store_dwordx4 v[36:39], v61, s[16:19], s27 offen
  buffer_store_dwordx4 v[40:43], v61, s[16:19], s27 offen offset:16
L1_nozf:
  s_nop 4
  ds_read_b32 v28, v14 offset:1024
  ds_read_b32 v32, v14 offset:1040
  ds_read_b32 v29, v14 offset:1536
  ds_read_b32 v33, v14 offset:1552
  ds_read_b32 v30, v14 offset:2048
  ds_read_b32 v34, v14 offset:2064
  ds_read_b32 v31, v14 offset:2560
  ds_read_b32 v35, v14 offset:2576
  v_mov_b32 v62, 3072
  ds_read_b128 v[52:55], v62
  ds_read_b128 v[56:59], v62 offset:16
  v_mov_b32 v20, 0
  v_mov_b32 v21, 0
  v_mov_b32 v22, 0
  v_mov_b32 v23, 0
  v_mov_b32 v24, 0
  v_mov_b32 v25, 0
  v_mov_b32 v26, 0
  v_mov_b32 v27, 0
  s_waitcnt lgkmcnt(0)
  v_max_f32 v62, v52, v53
  v_max3_f32 v62, v62, v54, v55
  v_sub_f32 v52, v52, v62
  v_sub_f32 v53, v53, v62
  v_sub_f32 v54, v54, v62
  v_sub_f32 v55, v55, v62
  v_exp_f32 v52, v52
  v_exp_f32 v53, v53
  v_exp_f32 v54, v54
  v_exp_f32 v55, v55
  v_mul_f32 v18, v28, v52
  v_mul_f32 v19, v32, v52
  v_mul_f32 v63, v56, v52
  v_fmac_f32 v18, v29, v53
  v_fmac_f32 v19, v33, v53
  v_fmac_f32 v63, v57, v53
  v_fmac_f32 v18, v30, v54
  v_fmac_f32 v19, v34, v54
  v_fmac_f32 v63, v58, v54
  v_fmac_f32 v18, v31, v55
  v_fmac_f32 v19, v35, v55
  v_fmac_f32 v63, v59, v55
  v_cvt_pk_bf16_f32 v12, v18, v19
  s_nop 1
  v_dot2c_f32_bf16_dpp v20, v12, v64 row_newbcast:0 row_mask:0xf bank_mask:0xf
  v_dot2c_f32_bf16_dpp v21, v12, v68 row_newbcast:0 row_mask:0xf bank_mask:0xf
  v_dot2c_f32_bf16_dpp v22, v12, v65 row_newbcast:0 row_mask:0xf bank_mask:0xf
  v_dot2c_f32_bf16_dpp v23, v12, v69 row_newbcast:0 row_mask:0xf bank_mask:0xf
  v_dot2c_f32_bf16_dpp v24, v12, v66 row_newbcast:0 row_mask:0xf bank_mask:0xf
  v_dot2c_f32_bf16_dpp v25, v12, v70 row_newbcast:0 row_mask:0xf bank_mask:0xf
  v_dot2c_f32_bf16_dpp v26, v12, v67 row_newbcast:0 row_mask:0xf bank_mask:0xf
  v_dot2c_f32_bf16_dpp v27, v12, v71 row_newbcast:0 row_mask:0xf bank_mask:0xf
  v_dot2c_f32_bf16_dpp v20, v12, v72 row_newbcast:1 row_mask:0xf bank_mask:0xf
  v_dot2c_f32_bf16_dpp v21, v12, v76 row_newbcast:1 row_mask:0xf bank_mask:0xf
  v_dot2c_f32_bf16_dpp v22, v12, v73 row_newbcast:1 row_mask:0xf bank_mask:0xf
  v_dot2c_f32_bf16_dpp v23, v12, v77 row_newbcast:1 row_mask:0xf bank_mask:0xf
  v_dot2c_f32_bf16_dpp v24, v12, v74 row_newbcast:1 row_mask:0xf bank_mask:0xf
  v_dot2c_f32_bf16_dpp v25, v12, v78 row_newbcast:1 row_mask:0xf bank_mask:0xf
  v_dot2c_f32_bf16_dpp v26, v12, v75 row_newbcast:1 row_mask:0xf bank_mask:0xf
  v_dot2c_f32_bf16_dpp v27, v12, v79 row_newbcast:1 row_mask:0xf bank_mask:0xf
  v_dot2c_f32_bf16_dpp v20, v12, v80 row_newbcast:2 row_mask:0xf bank_mask:0xf
  v_dot2c_f32_bf16_dpp v21, v12, v84 row_newbcast:2 row_mask:0xf bank_mask:0xf
  v_dot2c_f32_bf16_dpp v22, v12, v81 row_newbcast:2 row_mask:0xf bank_mask:0xf
  v_dot2c_f32_bf16_dpp v23, v12, v85 row_newbcast:2 row_mask:0xf bank_mask:0xf
  v_dot2c_f32_bf16_dpp v24, v12, v82 row_newbcast:2 row_mask:0xf bank_mask:0xf
  v_dot2c_f32_bf16_dpp v25, v12, v86 row_newbcast:2 row_mask:0xf bank_mask:0xf
  v_dot2c_f32_bf16_dpp v26, v12, v83 row_newbcast:2 row_mask:0xf bank_mask:0xf
  v_dot2c_f32_bf16_dpp v27, v12, v87 row_newbcast:2 row_mask:0xf bank_mask:0xf
  v_dot2c_f32_bf16_dpp v20, v12, v88 row_newbcast:3 row_mask:0xf bank_mask:0xf
  v_dot2c_f32_bf16_dpp v21, v12, v92 row_newbcast:3 row_mask:0xf bank_mask:0xf
  v_dot2c_f32_bf16_dpp v22, v12, v89 row_newbcast:3 row_mask:0xf bank_mask:0xf
  v_dot2c_f32_bf16_dpp v23, v12, v93 row_newbcast:3 row_mask:0xf bank_mask:0xf
  v_dot2c_f32_bf16_dpp v24, v12, v90 row_newbcast:3 row_mask:0xf bank_mask:0xf
  v_dot2c_f32_bf16_dpp v25, v12, v94 row_newbcast:3 row_mask:0xf bank_mask:0xf
  v_dot2c_f32_bf16_dpp v26, v12, v91 row_newbcast:3 row_mask:0xf bank_mask:0xf
  v_dot2c_f32_bf16_dpp v27, v12, v95 row_newbcast:3 row_mask:0xf bank_mask:0xf
  v_dot2c_f32_bf16_dpp v20, v12, v96 row_newbcast:4 row_mask:0xf bank_mask:0xf
  v_dot2c_f32_bf16_dpp v21, v12, v100 row_newbcast:4 row_mask:0xf bank_mask:0xf
  v_dot2c_f32_bf16_dpp v22, v12, v97 row_newbcast:4 row_mask:0xf bank_mask:0xf
  v_dot2c_f32_bf16_dpp v23, v12, v101 row_newbcast:4 row_mask:0xf bank_mask:0xf
  v_dot2c_f32_bf16_dpp v24, v12, v98 row_newbcast:4 row_mask:0xf bank_mask:0xf
  v_dot2c_f32_bf16_dpp v25, v12, v102 row_newbcast:4 row_mask:0xf bank_mask:0xf
  v_dot2c_f32_bf16_dpp v26, v12, v99 row_newbcast:4 row_mask:0xf bank_mask:0xf
  v_dot2c_f32_bf16_dpp v27, v12, v103 row_newbcast:4 row_mask:0xf bank_mask:0xf
  v_dot2c_f32_bf16_dpp v20, v12, v104 row_newbcast:5 row_mask:0xf bank_mask:0xf
  v_dot2c_f32_bf16_dpp v21, v12, v108 row_newbcast:5 row_mask:0xf bank_mask:0xf
  v_dot2c_f32_bf16_dpp v22, v12, v105 row_newbcast:5 row_mask:0xf bank_mask:0xf
  v_dot2c_f32_bf16_dpp v23, v12, v109 row_newbcast:5 row_mask:0xf bank_mask:0xf
  v_dot2c_f32_bf16_dpp v24, v12, v106 row_newbcast:5 row_mask:0xf bank_mask:0xf
  v_dot2c_f32_bf16_dpp v25, v12, v110 row_newbcast:5 row_mask:0xf bank_mask:0xf
  v_dot2c_f32_bf16_dpp v26, v12, v107 row_newbcast:5 row_mask:0xf bank_mask:0xf
  v_dot2c_f32_bf16_dpp v27, v12, v111 row_newbcast:5 row_mask:0xf bank_mask:0xf
  v_dot2c_f32_bf16_dpp v20, v12, v112 row_newbcast:6 row_mask:0xf bank_mask:0xf
  v_dot2c_f32_bf16_dpp v21, v12, v116 row_newbcast:6 row_mask:0xf bank_mask:0xf
  v_dot2c_f32_bf16_dpp v22, v12, v113 row_newbcast:6 row_mask:0xf bank_mask:0xf
  v_dot2c_f32_bf16_dpp v23, v12, v117 row_newbcast:6 row_mask:0xf bank_mask:0xf
  v_dot2c_f32_bf16_dpp v24, v12, v114 row_newbcast:6 row_mask:0xf bank_mask:0xf
  v_dot2c_f32_bf16_dpp v25, v12, v118 row_newbcast:6 row_mask:0xf bank_mask:0xf
  v_dot2c_f32_bf16_dpp v26, v12, v115 row_newbcast:6 row_mask:0xf bank_mask:0xf
  v_dot2c_f32_bf16_dpp v27, v12, v119 row_newbcast:6 row_mask:0xf bank_mask:0xf
  v_dot2c_f32_bf16_dpp v20, v12, v120 row_newbcast:7 row_mask:0xf bank_mask:0xf
  v_dot2c_f32_bf16_dpp v21, v12, v124 row_newbcast:7 row_mask:0xf bank_mask:0xf
  v_dot2c_f32_bf16_dpp v22, v12, v121 row_newbcast:7 row_mask:0xf bank_mask:0xf
  v_dot2c_f32_bf16_dpp v23, v12, v125 row_newbcast:7 row_mask:0xf bank_mask:0xf
  v_dot2c_f32_bf16_dpp v24, v12, v122 row_newbcast:7 row_mask:0xf bank_mask:0xf
  v_dot2c_f32_bf16_dpp v25, v12, v126 row_newbcast:7 row_mask:0xf bank_mask:0xf
  v_dot2c_f32_bf16_dpp v26, v12, v123 row_newbcast:7 row_mask:0xf bank_mask:0xf
  v_dot2c_f32_bf16_dpp v27, v12, v127 row_newbcast:7 row_mask:0xf bank_mask:0xf
  v_dot2c_f32_bf16_dpp v20, v12, v128 row_newbcast:8 row_mask:0xf bank_mask:0xf
  v_dot2c_f32_bf16_dpp v21, v12, v132 row_newbcast:8 row_mask:0xf bank_mask:0xf
  v_dot2c_f32_bf16_dpp v22, v12, v129 row_newbcast:8 row_mask:0xf bank_mask:0xf
  v_dot2c_f32_bf16_dpp v23, v12, v133 row_newbcast:8 row_mask:0xf bank_mask:0xf
  v_dot2c_f32_bf16_dpp v24, v12, v130 row_newbcast:8 row_mask:0xf bank_mask:0xf
  v_dot2c_f32_bf16_dpp v25, v12, v134 row_newbcast:8 row_mask:0xf bank_mask:0xf
  v_dot2c_f32_bf16_dpp v26, v12, v131 row_newbcast:8 row_mask:0xf bank_mask:0xf
  v_dot2c_f32_bf16_dpp v27, v12, v135 row_newbcast:8 row_mask:0xf bank_mask:0xf
  v_dot2c_f32_bf16_dpp v20, v12, v136 row_newbcast:9 row_mask:0xf bank_mask:0xf
  v_dot2c_f32_bf16_dpp v21, v12, v140 row_newbcast:9 row_mask:0xf bank_mask:0xf
  v_dot2c_f32_bf16_dpp v22, v12, v137 row_newbcast:9 row_mask:0xf bank_mask:0xf
  v_dot2c_f32_bf16_dpp v23, v12, v141 row_newbcast:9 row_mask:0xf bank_mask:0xf
  v_dot2c_f32_bf16_dpp v24, v12, v138 row_newbcast:9 row_mask:0xf bank_mask:0xf
  v_dot2c_f32_bf16_dpp v25, v12, v142 row_newbcast:9 row_mask:0xf bank_mask:0xf
  v_dot2c_f32_bf16_dpp v26, v12, v139 row_newbcast:9 row_mask:0xf bank_mask:0xf
  v_dot2c_f32_bf16_dpp v27, v12, v143 row_newbcast:9 row_mask:0xf bank_mask:0xf
  v_dot2c_f32_bf16_dpp v20, v12, v144 row_newbcast:10 row_mask:0xf bank_mask:0xf
  v_dot2c_f32_bf16_dpp v21, v12, v148 row_newbcast:10 row_mask:0xf bank_mask:0xf
  v_dot2c_f32_bf16_dpp v22, v12, v145 row_newbcast:10 row_mask:0xf bank_mask:0xf
  v_dot2c_f32_bf16_dpp v23, v12, v149 row_newbcast:10 row_mask:0xf bank_mask:0xf
  v_dot2c_f32_bf16_dpp v24, v12, v146 row_newbcast:10 row_mask:0xf bank_mask:0xf
  v_dot2c_f32_bf16_dpp v25, v12, v150 row_newbcast:10 row_mask:0xf bank_mask:0xf
  v_dot2c_f32_bf16_dpp v26, v12, v147 row_newbcast:10 row_mask:0xf bank_mask:0xf
  v_dot2c_f32_bf16_dpp v27, v12, v151 row_newbcast:10 row_mask:0xf bank_mask:0xf
  v_dot2c_f32_bf16_dpp v20, v12, v152 row_newbcast:11 row_mask:0xf bank_mask:0xf
  v_dot2c_f32_bf16_dpp v21, v12, v156 row_newbcast:11 row_mask:0xf bank_mask:0xf
  v_dot2c_f32_bf16_dpp v22, v12, v153 row_newbcast:11 row_mask:0xf bank_mask:0xf
  v_dot2c_f32_bf16_dpp v23, v12, v157 row_newbcast:11 row_mask:0xf bank_mask:0xf
  v_dot2c_f32_bf16_dpp v24, v12, v154 row_newbcast:11 row_mask:0xf bank_mask:0xf
  v_dot2c_f32_bf16_dpp v25, v12, v158 row_newbcast:11 row_mask:0xf bank_mask:0xf
  v_dot2c_f32_bf16_dpp v26, v12, v155 row_newbcast:11 row_mask:0xf bank_mask:0xf
  v_dot2c_f32_bf16_dpp v27, v12, v159 row_newbcast:11 row_mask:0xf bank_mask:0xf
  v_dot2c_f32_bf16_dpp v20, v12, v160 row_newbcast:12 row_mask:0xf bank_mask:0xf
  v_dot2c_f32_bf16_dpp v21, v12, v164 row_newbcast:12 row_mask:0xf bank_mask:0xf
  v_dot2c_f32_bf16_dpp v22, v12, v161 row_newbcast:12 row_mask:0xf bank_mask:0xf
  v_dot2c_f32_bf16_dpp v23, v12, v165 row_newbcast:12 row_mask:0xf bank_mask:0xf
  v_dot2c_f32_bf16_dpp v24, v12, v162 row_newbcast:12 row_mask:0xf bank_mask:0xf
  v_dot2c_f32_bf16_dpp v25, v12, v166 row_newbcast:12 row_mask:0xf bank_mask:0xf
  v_dot2c_f32_bf16_dpp v26, v12, v163 row_newbcast:12 row_mask:0xf bank_mask:0xf
  v_dot2c_f32_bf16_dpp v27, v12, v167 row_newbcast:12 row_mask:0xf bank_mask:0xf
  v_dot2c_f32_bf16_dpp v20, v12, v168 row_newbcast:13 row_mask:0xf bank_mask:0xf
  v_dot2c_f32_bf16_dpp v21, v12, v172 row_newbcast:13 row_mask:0xf bank_mask:0xf
  v_dot2c_f32_bf16_dpp v22, v12, v169 row_newbcast:13 row_mask:0xf bank_mask:0xf
  v_dot2c_f32_bf16_dpp v23, v12, v173 row_newbcast:13 row_mask:0xf bank_mask:0xf
  v_dot2c_f32_bf16_dpp v24, v12, v170 row_newbcast:13 row_mask:0xf bank_mask:0xf
  v_dot2c_f32_bf16_dpp v25, v12, v174 row_newbcast:13 row_mask:0xf bank_mask:0xf
  v_dot2c_f32_bf16_dpp v26, v12, v171 row_newbcast:13 row_mask:0xf bank_mask:0xf
  v_dot2c_f32_bf16_dpp v27, v12, v175 row_newbcast:13 row_mask:0xf bank_mask:0xf
  v_dot2c_f32_bf16_dpp v20, v12, v176 row_newbcast:14 row_mask:0xf bank_mask:0xf
  v_dot2c_f32_bf16_dpp v21, v12, v180 row_newbcast:14 row_mask:0xf bank_mask:0xf
  v_dot2c_f32_bf16_dpp v22, v12, v177 row_newbcast:14 row_mask:0xf bank_mask:0xf
  v_dot2c_f32_bf16_dpp v23, v12, v181 row_newbcast:14 row_mask:0xf bank_mask:0xf
  v_dot2c_f32_bf16_dpp v24, v12, v178 row_newbcast:14 row_mask:0xf bank_mask:0xf
  v_dot2c_f32_bf16_dpp v25, v12, v182 row_newbcast:14 row_mask:0xf bank_mask:0xf
  v_dot2c_f32_bf16_dpp v26, v12, v179 row_newbcast:14 row_mask:0xf bank_mask:0xf
  v_dot2c_f32_bf16_dpp v27, v12, v183 row_newbcast:14 row_mask:0xf bank_mask:0xf
  v_dot2c_f32_bf16_dpp v20, v12, v184 row_newbcast:15 row_mask:0xf bank_mask:0xf
  v_dot2c_f32_bf16_dpp v21, v12, v188 row_newbcast:15 row_mask:0xf bank_mask:0xf
  v_dot2c_f32_bf16_dpp v22, v12, v185 row_newbcast:15 row_mask:0xf bank_mask:0xf
  v_dot2c_f32_bf16_dpp v23, v12, v189 row_newbcast:15 row_mask:0xf bank_mask:0xf
  v_dot2c_f32_bf16_dpp v24, v12, v186 row_newbcast:15 row_mask:0xf bank_mask:0xf
  v_dot2c_f32_bf16_dpp v25, v12, v190 row_newbcast:15 row_mask:0xf bank_mask:0xf
  v_dot2c_f32_bf16_dpp v26, v12, v187 row_newbcast:15 row_mask:0xf bank_mask:0xf
  v_dot2c_f32_bf16_dpp v27, v12, v191 row_newbcast:15 row_mask:0xf bank_mask:0xf
  v_permlane32_swap_b32 v20, v24
  v_permlane32_swap_b32 v21, v25
  v_permlane32_swap_b32 v22, v26
  v_permlane32_swap_b32 v23, v27
  v_add_f32 v20, v20, v24
  v_add_f32 v21, v21, v25
  v_add_f32 v22, v22, v26
  v_add_f32 v23, v23, v27
  s_nop 0
  v_permlane16_swap_b32 v20, v22
  v_permlane16_swap_b32 v21, v23
  v_add_f32 v20, v20, v22
  v_add_f32 v21, v21, v23
  v_lshlrev_b32 v61, 1, v5
  s_lshl_b32 s27, s72, 9
  s_add_u32 s27, s27, s82
  buffer_store_dwordx2 v[20:21], v61, s[16:19], s27 offen
  s_cmp_lg_u32 s72, 0
  s_cbranch_scc1 L1_done
  s_lshr_b32 s27, s82, 8
  s_add_u32 s27, s27, 1048576
  v_mov_b32 v61, 0
  s_mov_b64 exec, 1
  buffer_store_dwordx2 v[62:63], v61, s[16:19], s27 offen
L1_done:
  s_endpgm
.globl final_reduce_kernel
.p2align 8
.type final_reduce_kernel,@function
final_reduce_kernel:
  s_cmp_ge_u32 s2, 32
  s_cbranch_scc1 L2_done
  s_load_dwordx2 s[4:5], s[0:1], 0
  s_load_dwordx2 s[8:9], s[0:1], 72
  s_load_dwordx2 s[12:13], s[0:1], 88
  v_lshrrev_b32 v2, 6, v0
  v_and_b32 v1, 63, v0
  v_readfirstlane_b32 s20, v2
  s_lshr_b32 s21, s2, 3
  s_and_b32 s22, s2, 7
  s_mov_b32 s6, 4096
  s_mov_b32 s7, 0x00020000
  s_mov_b32 s10, 4096
  s_mov_b32 s11, 0x00020000
  s_mov_b32 s14, 4194304
  s_mov_b32 s15, 0x00020000
  s_lshl_b32 s23, s21, 6
  s_lshl_b32 s24, s20, 4
  s_add_u32 s23, s23, s24
  s_lshl_b32 s24, s23, 11
  s_lshl_b32 s25, s22, 8
  s_add_u32 s24, s24, s25
  s_add_u32 s25, s24, 524288
  s_lshl_b32 s26, s23, 3
  s_add_u32 s26, s26, 1048576
  v_lshlrev_b32 v3, 2, v1
  v_and_b32 v4, 15, v1
  v_lshlrev_b32 v4, 3, v4
  v_lshlrev_b32 v5, 1, v1
  s_lshl_b32 s27, s21, 10
  s_lshl_b32 s28, s22, 7
  s_add_u32 s27, s27, s28
  s_waitcnt lgkmcnt(0)
  buffer_load_dwordx2 v[6:7], v4, s[12:15], s26 offen
  buffer_load_dword v16, v3, s[12:15], s24 offen offset:0
  buffer_load_dword v17, v3, s[12:15], s24 offen offset:2048
  s_add_u32 s24, s24, 4096
  buffer_load_dword v18, v3, s[12:15], s24 offen offset:0
  buffer_load_dword v19, v3, s[12:15], s24 offen offset:2048
  s_add_u32 s24, s24, 4096
  buffer_load_dword v20, v3, s[12:15], s24 offen offset:0
  buffer_load_dword v21, v3, s[12:15], s24 offen offset:2048
  s_add_u32 s24, s24, 4096
  buffer_load_dword v22, v3, s[12:15], s24 offen offset:0
  buffer_load_dword v23, v3, s[12:15], s24 offen offset:2048
  s_add_u32 s24, s24, 4096
  buffer_load_dword v24, v3, s[12:15], s24 offen offset:0
  buffer_load_dword v25, v3, s[12:15], s24 offen offset:2048
  s_add_u32 s24, s24, 4096
  buffer_load_dword v26, v3, s[12:15], s24 offen offset:0
  buffer_load_dword v27, v3, s[12:15], s24 offen offset:2048
  s_add_u32 s24, s24, 4096
  buffer_load_dword v28, v3, s[12:15], s24 offen offset:0
  buffer_load_dword v29, v3, s[12:15], s24 offen offset:2048
  s_add_u32 s24, s24, 4096
  buffer_load_dword v30, v3, s[12:15], s24 offen offset:0
  buffer_load_dword v31, v3, s[12:15], s24 offen offset:2048
  s_add_u32 s24, s24, 4096
  buffer_load_dword v32, v3, s[12:15], s25 offen offset:0
  buffer_load_dword v33, v3, s[12:15], s25 offen offset:2048
  s_add_u32 s25, s25, 4096
  buffer_load_dword v34, v3, s[12:15], s25 offen offset:0
  buffer_load_dword v35, v3, s[12:15], s25 offen offset:2048
  s_add_u32 s25, s25, 4096
  buffer_load_dword v36, v3, s[12:15], s25 offen offset:0
  buffer_load_dword v37, v3, s[12:15], s25 offen offset:2048
  s_add_u32 s25, s25, 4096
  buffer_load_dword v38, v3, s[12:15], s25 offen offset:0
  buffer_load_dword v39, v3, s[12:15], s25 offen offset:2048
  s_add_u32 s25, s25, 4096
  s_cmp_eq_u32 s20, 3
  s_cselect_b32 s25, 0x40000000, s25
  buffer_load_dword v40, v3, s[12:15], s25 offen offset:0
  buffer_load_dword v41, v3, s[12:15], s25 offen offset:2048
  s_add_u32 s25, s25, 4096
  buffer_load_dword v42, v3, s[12:15], s25 offen offset:0
  buffer_load_dword v43, v3, s[12:15], s25 offen offset:2048
  s_add_u32 s25, s25, 4096
  buffer_load_dword v44, v3, s[12:15], s25 offen offset:0
  buffer_load_dword v45, v3, s[12:15], s25 offen offset:2048
  s_add_u32 s25, s25, 4096
  buffer_load_dword v46, v3, s[12:15], s25 offen offset:0
  buffer_load_dword v47, v3, s[12:15], s25 offen offset:2048
  s_add_u32 s25, s25, 4096
  buffer_load_ushort v8, v5, s[4:7], s27 offen
  s_waitcnt vmcnt(33)
  v_max_f32_dpp v9, v6, v6 quad_perm:[1,0,3,2] row_mask:0xf bank_mask:0xf
  v_sub_f32 v9, v6, v9
  v_exp_f32 v9, v9
  s_nop 0
  v_mul_f32 v10, v7, v9
  s_nop 1
  v_add_f32_dpp v10, v10, v10 quad_perm:[1,0,3,2] row_mask:0xf bank_mask:0xf
  v_rcp_f32 v11, v10
  s_nop 0
  v_fma_f32 v12, -v10, v11, 1.0
  v_fma_f32 v11, v12, v11, v11
  v_mul_f32 v9, v9, v11
  v_mov_b32 v12, 0
  v_mov_b32 v13, 0
  s_waitcnt vmcnt(32)
  v_fmac_f32_dpp v12, v9, v16 row_newbcast:0 row_mask:0xf bank_mask:0xf
  s_waitcnt vmcnt(31)
  s_nop 0
  v_fmac_f32_dpp v12, v9, v17 row_newbcast:1 row_mask:0xf bank_mask:0xf
  s_waitcnt vmcnt(30)
  s_nop 0
  v_fmac_f32_dpp v12, v9, v18 row_newbcast:2 row_mask:0xf bank_mask:0xf
  s_waitcnt vmcnt(29)
  s_nop 0
  v_fmac_f32_dpp v12, v9, v19 row_newbcast:3 row_mask:0xf bank_mask:0xf
  s_waitcnt vmcnt(28)
  s_nop 0
  v_fmac_f32_dpp v12, v9, v20 row_newbcast:4 row_mask:0xf bank_mask:0xf
  s_waitcnt vmcnt(27)
  s_nop 0
  v_fmac_f32_dpp v12, v9, v21 row_newbcast:5 row_mask:0xf bank_mask:0xf
  s_waitcnt vmcnt(26)
  s_nop 0
  v_fmac_f32_dpp v12, v9, v22 row_newbcast:6 row_mask:0xf bank_mask:0xf
  s_waitcnt vmcnt(25)
  s_nop 0
  v_fmac_f32_dpp v12, v9, v23 row_newbcast:7 row_mask:0xf bank_mask:0xf
  s_waitcnt vmcnt(24)
  s_nop 0
  v_fmac_f32_dpp v12, v9, v24 row_newbcast:8 row_mask:0xf bank_mask:0xf
  s_waitcnt vmcnt(23)
  s_nop 0
  v_fmac_f32_dpp v12, v9, v25 row_newbcast:9 row_mask:0xf bank_mask:0xf
  s_waitcnt vmcnt(22)
  s_nop 0
  v_fmac_f32_dpp v12, v9, v26 row_newbcast:10 row_mask:0xf bank_mask:0xf
  s_waitcnt vmcnt(21)
  s_nop 0
  v_fmac_f32_dpp v12, v9, v27 row_newbcast:11 row_mask:0xf bank_mask:0xf
  s_waitcnt vmcnt(20)
  s_nop 0
  v_fmac_f32_dpp v12, v9, v28 row_newbcast:12 row_mask:0xf bank_mask:0xf
  s_waitcnt vmcnt(19)
  s_nop 0
  v_fmac_f32_dpp v12, v9, v29 row_newbcast:13 row_mask:0xf bank_mask:0xf
  s_waitcnt vmcnt(18)
  s_nop 0
  v_fmac_f32_dpp v12, v9, v30 row_newbcast:14 row_mask:0xf bank_mask:0xf
  s_waitcnt vmcnt(17)
  s_nop 0
  v_fmac_f32_dpp v12, v9, v31 row_newbcast:15 row_mask:0xf bank_mask:0xf
  s_waitcnt vmcnt(16)
  v_add_f32 v13, v13, v32
  s_waitcnt vmcnt(15)
  v_add_f32 v13, v13, v33
  s_waitcnt vmcnt(14)
  v_add_f32 v13, v13, v34
  s_waitcnt vmcnt(13)
  v_add_f32 v13, v13, v35
  s_waitcnt vmcnt(12)
  v_add_f32 v13, v13, v36
  s_waitcnt vmcnt(11)
  v_add_f32 v13, v13, v37
  s_waitcnt vmcnt(10)
  v_add_f32 v13, v13, v38
  s_waitcnt vmcnt(9)
  v_add_f32 v13, v13, v39
  s_waitcnt vmcnt(8)
  v_add_f32 v13, v13, v40
  s_waitcnt vmcnt(7)
  v_add_f32 v13, v13, v41
  s_waitcnt vmcnt(6)
  v_add_f32 v13, v13, v42
  s_waitcnt vmcnt(5)
  v_add_f32 v13, v13, v43
  s_waitcnt vmcnt(4)
  v_add_f32 v13, v13, v44
  s_waitcnt vmcnt(3)
  v_add_f32 v13, v13, v45
  s_waitcnt vmcnt(2)
  v_add_f32 v13, v13, v46
  s_waitcnt vmcnt(1)
  v_add_f32 v13, v13, v47
  v_lshlrev_b32 v14, 3, v0
  ds_write_b64 v14, v[12:13]
  s_waitcnt lgkmcnt(0)
  s_barrier
  s_cmp_lg_u32 s20, 0
  s_cbranch_scc1 L2_done
  ds_read_b64 v[16:17], v14 offset:512
  ds_read_b64 v[18:19], v14 offset:1024
  ds_read_b64 v[20:21], v14 offset:1536
  s_waitcnt vmcnt(0) lgkmcnt(0)
  v_add_f32 v12, v12, v16
  v_add_f32 v18, v18, v20
  v_add_f32 v13, v13, v17
  v_add_f32 v19, v19, v21
  v_add_f32 v12, v12, v18
  v_add_f32 v13, v13, v19
  v_cvt_pk_bf16_f32 v12, v12, v13
  v_lshlrev_b32 v8, 16, v8
  v_lshlrev_b32 v13, 16, v12
  v_and_b32 v12, 0xffff0000, v12
  v_add_f32 v8, v8, v13
  v_cvt_pk_bf16_f32 v8, v8, v8
  v_lshlrev_b32 v8, 16, v8
  v_add_f32 v8, v8, v12
  v_cvt_pk_bf16_f32 v8, v8, v8
  buffer_store_short v8, v5, s[8:11], s27 offen
L2_done:
  s_endpgm
.section .rodata,"a"
.p2align 6
.amdhsa_kernel parallel_sum__mha_block_cached__swiglu_ffn__decode_kernel
  .amdhsa_next_free_vgpr 256
  .amdhsa_next_free_sgpr 100
  .amdhsa_accum_offset 256
  .amdhsa_group_segment_fixed_size 0
  .amdhsa_kernarg_size 96
  .amdhsa_user_sgpr_count 2
  .amdhsa_user_sgpr_kernarg_segment_ptr 1
  .amdhsa_system_sgpr_workgroup_id_x 1
.end_amdhsa_kernel
.p2align 6
.amdhsa_kernel final_reduce_kernel
  .amdhsa_next_free_vgpr 48
  .amdhsa_next_free_sgpr 40
  .amdhsa_accum_offset 48
  .amdhsa_group_segment_fixed_size 0
  .amdhsa_kernarg_size 96
  .amdhsa_user_sgpr_count 2
  .amdhsa_user_sgpr_kernarg_segment_ptr 1
  .amdhsa_system_sgpr_workgroup_id_x 1
.end_amdhsa_kernel
```
